```python
import torch

def _softmax(x, axis=-1):
    return torch.softmax(x, dim=axis)

def _gelu(x):
    return torch.nn.functional.gelu(x, approximate='tanh')

def _silu(x):
    return torch.nn.functional.silu(x)

def _sigmoid(x):
    return torch.sigmoid(x)

def _layernorm(x, axis=-1, eps=1e-05):
    m = x.mean(dim=axis, keepdim=True)
    v = x.var(dim=axis, keepdim=True, unbiased=False)
    return (x - m) / torch.sqrt(v + eps)

def _scatter_add(tgt, idx, src, axis=0):
    return tgt.clone().index_add_(axis, idx, src)

def _segment_sum(src, seg, n):
    out = torch.zeros((n,) + src.shape[1:], dtype=src.dtype)
    return out.index_add_(0, seg, src)

def _pad(x, pw):
    flat = tuple((v for pair in reversed(pw) for v in pair))
    return torch.nn.functional.pad(x, flat)
kernel_name = 'adaLN_cond__compressed_kv_cla__dense_activation_relu__decode'

def setup_inputs():

    _w = lambda a: (lambda t: t.to(torch.bfloat16) if t.is_floating_point() else t)(torch.as_tensor(a))

    def _A_setup():
        B, H, Sq, Sk, D, M = (1, 32, 1, 32768, 128, 640)
        Dc = 4 * D
        return {'x': _w((lambda *s: torch.randn(*s, dtype=torch.bfloat16) * 0.05)(B, Sq, M)), 'c_kv': _w((lambda *s: torch.randn(*s, dtype=torch.bfloat16) * 1.6)(B, Sk, Dc)), 'w_q': _w((lambda *s: torch.randn(*s, dtype=torch.bfloat16) * 1.6)(M, H, D) * M ** (-0.5)), 'w_uk': _w((lambda *s: torch.randn(*s, dtype=torch.bfloat16) * 1.6)(Dc, H, D) * Dc ** (-0.5)), 'w_uv': _w((lambda *s: torch.randn(*s, dtype=torch.bfloat16) * 1.6)(Dc, H, D) * Dc ** (-0.5)), 'w_o': _w((lambda *s: torch.randn(*s, dtype=torch.bfloat16) * 1.6)(H, D, M) * (H * D) ** (-0.5))}
    _A_in = _A_setup()

    def _B_setup():
        B, S, D, Dff = (1, 1, 640, 1728)
        return {'x': _w((lambda *s: torch.randn(*s, dtype=torch.bfloat16) * 0.05)(B, S, D)), 'w1': _w((lambda *s: torch.randn(*s, dtype=torch.bfloat16) * 0.05)(D, Dff)), 'w2': _w((lambda *s: torch.randn(*s, dtype=torch.bfloat16) * 0.05)(Dff, D))}
    _B_in = _B_setup()
    return {'A_x': _A_in['x'], 'A_c_kv': _A_in['c_kv'], 'A_w_q': _A_in['w_q'], 'A_w_uk': _A_in['w_uk'], 'A_w_uv': _A_in['w_uv'], 'A_w_o': _A_in['w_o'], 'B_x': _B_in['x'], 'B_w1': _B_in['w1'], 'B_w2': _B_in['w2'], 'c': _w((lambda *s: torch.randn(*s, dtype=torch.bfloat16) * 0.2)(1, 640) * 8.0), 'w_mod': _w((lambda *s: torch.randn(*s, dtype=torch.bfloat16) * 0.2)(640, 6 * 640) * 640 ** (-0.5) * 8.0)}

def reference(A_x, A_c_kv, A_w_q, A_w_uk, A_w_uv, A_w_o, B_x, B_w1, B_w2, c, w_mod):

    def _A_ref(x, c_kv, w_q, w_uk, w_uv, w_o):
        B, Sq, M = (x.shape[0], x.shape[1], x.shape[2])
        Sk = c_kv.shape[1]
        H, D = (w_q.shape[1], w_q.shape[2])
        q = torch.einsum('bqm,mhd->bhqd', x, w_q)
        k = torch.einsum('bkc,chd->bhkd', c_kv, w_uk)
        v = torch.einsum('bkc,chd->bhkd', c_kv, w_uv)
        scores = torch.einsum('bhqd,bhkd->bhqk', q, k) * D ** (-0.5)
        off = Sk - Sq
        qi = torch.arange(Sq)[:, None]
        kj = torch.arange(Sk)[None, :]
        cmask = kj <= qi + off
        scores = torch.where(cmask[None, None], scores, -1000000000.0)
        p = _softmax(scores, axis=-1)
        ctx = torch.einsum('bhqk,bhkd->bhqd', p, v)
        return torch.einsum('bhqd,hdm->bqm', ctx, w_o)

    def _B_ref(x, w1, w2):
        h = torch.einsum('bsd,df->bsf', x, w1)
        zero = torch.zeros_like(h)
        h = torch.maximum(h, zero)
        return torch.einsum('bsf,fd->bsd', h, w2)
    x = A_x
    mod = (_silu(c) @ w_mod).reshape(c.shape[0], 6, 1, -1)
    sa, ca, ga, sb, cb, gb = (mod[:, 0].clone(), mod[:, 1].clone(), mod[:, 2].clone(), mod[:, 3].clone(), mod[:, 4].clone(), mod[:, 5].clone())
    h = _layernorm(x, axis=-1) * (1 + ca) + sa
    x = x + ga * _A_ref(h, A_c_kv, A_w_q, A_w_uk, A_w_uv, A_w_o)
    h = _layernorm(x, axis=-1) * (1 + cb) + sb
    x = x + gb * _B_ref(h, B_w1, B_w2)
    return x
```

```asm
; @launch grid=(256,1,1) block=(256,1,1) lds=163840
.amdgcn_target "amdgcn-amd-amdhsa--gfx950"
.text
.globl adaLN_cond__compressed_kv_cla__dense_activation_relu__decode_kernel
.p2align 8
.type adaLN_cond__compressed_kv_cla__dense_activation_relu__decode_kernel,@function
adaLN_cond__compressed_kv_cla__dense_activation_relu__decode_kernel:
s_cmp_ge_u32 s2, 256
s_cbranch_scc1 L_exit
s_load_dwordx16 s[36:51], s[0:1], 0
s_load_dwordx8 s[52:59], s[0:1], 64
s_load_dwordx4 s[60:63], s[0:1], 96
s_getpc_b64 s[30:31]
L_pc:
s_lshr_b32 s23, s2, 3
s_mul_i32 s23, s23, 1024
v_lshlrev_b32 v4, 6, v0
v_add_u32 v4, s23, v4
v_min_u32 v4, L_exit - L_pc, v4
v_cmp_gt_u32 vcc, 16, v0
s_and_saveexec_b64 s[28:29], vcc
s_cbranch_execz L_nopf
global_load_dword v250, v4, s[30:31]
L_nopf:
s_mov_b64 exec, s[28:29]
v_and_b32 v1, 63, v0
v_lshrrev_b32 v2, 6, v0
s_mov_b32 s24, 0x05040100
s_mov_b32 s25, 0x07060302
v_readfirstlane_b32 s21, v2
s_lshr_b32 s23, s2, 3
s_and_b32 s27, s23, 15
s_lshl_b32 s27, s27, 3
s_and_b32 s30, s2, 7
s_or_b32 s22, s27, s30
s_waitcnt lgkmcnt(0)
s_mov_b32 s4, s62
s_mov_b32 s5, s63
s_mov_b32 s6, 0x10000000
s_mov_b32 s7, 0x20000
s_load_dword s20, s[62:63], 0
s_getreg_b32 s83, hwreg(HW_REG_XCC_ID)
s_and_b32 s83, s83, 15
s_add_u32 s83, s83, 1
s_cmp_ge_u32 s21, 4
s_cselect_b32 s100, 16384, 0
s_cmp_ge_u32 s23, 16
s_cbranch_scc1 L_roleA
s_cmp_ge_u32 s21, 4
s_cbranch_scc1 L_exit
s_and_b32 s27, s22, 7
s_lshl_b32 s27, s27, 2
s_bfe_u32 s30, s22, 0x20003
s_add_u32 s31, s27, s30
s_lshr_b32 s32, s22, 5
s_lshl_b32 s101, s31, 2
s_add_u32 s101, s101, s32
v_lshrrev_b32 v3, 4, v0
v_and_b32 v4, 15, v0
s_mov_b32 s8, s40
s_mov_b32 s9, s41
s_mov_b32 s10, 0x500000
s_mov_b32 s11, 0x20000
s_mov_b32 s12, s42
s_mov_b32 s13, s43
s_mov_b32 s14, 0x400000
s_mov_b32 s15, 0x20000
s_mov_b32 s27, 81920
v_mul_lo_u32 v10, v3, s27
v_lshl_add_u32 v10, v4, 4, v10
s_mul_i32 s27, s32, 1310720
s_lshl_b32 s30, s31, 8
s_add_u32 s27, s27, s30
s_add_u32 s30, s27, 0
buffer_load_dwordx4 v[64:67], v10, s[8:11], s30 offen nt
s_add_u32 s30, s27, 8192
buffer_load_dwordx4 v[68:71], v10, s[8:11], s30 offen nt
s_add_u32 s30, s27, 16384
buffer_load_dwordx4 v[72:75], v10, s[8:11], s30 offen nt
s_add_u32 s30, s27, 24576
buffer_load_dwordx4 v[76:79], v10, s[8:11], s30 offen nt
s_add_u32 s30, s27, 32768
buffer_load_dwordx4 v[80:83], v10, s[8:11], s30 offen nt
s_add_u32 s30, s27, 40960
buffer_load_dwordx4 v[84:87], v10, s[8:11], s30 offen nt
s_add_u32 s30, s27, 49152
buffer_load_dwordx4 v[88:91], v10, s[8:11], s30 offen nt
s_add_u32 s30, s27, 57344
buffer_load_dwordx4 v[92:95], v10, s[8:11], s30 offen nt
s_add_u32 s30, s27, 65536
buffer_load_dwordx4 v[96:99], v10, s[8:11], s30 offen nt
s_add_u32 s30, s27, 73728
buffer_load_dwordx4 v[100:103], v10, s[8:11], s30 offen nt
v_lshlrev_b32 v11, 16, v3
v_lshl_add_u32 v11, v4, 4, v11
s_lshl_b32 s27, s32, 20
s_lshl_b32 s30, s31, 8
s_add_u32 s27, s27, s30
s_add_u32 s30, s27, 0
buffer_load_dwordx4 v[104:107], v11, s[12:15], s30 offen nt
s_add_u32 s30, s27, 8192
buffer_load_dwordx4 v[108:111], v11, s[12:15], s30 offen nt
s_add_u32 s30, s27, 16384
buffer_load_dwordx4 v[112:115], v11, s[12:15], s30 offen nt
s_add_u32 s30, s27, 24576
buffer_load_dwordx4 v[116:119], v11, s[12:15], s30 offen nt
s_add_u32 s30, s27, 32768
buffer_load_dwordx4 v[120:123], v11, s[12:15], s30 offen nt
s_add_u32 s30, s27, 40960
buffer_load_dwordx4 v[124:127], v11, s[12:15], s30 offen nt
s_add_u32 s30, s27, 49152
buffer_load_dwordx4 v[128:131], v11, s[12:15], s30 offen nt
s_add_u32 s30, s27, 57344
buffer_load_dwordx4 v[132:135], v11, s[12:15], s30 offen nt
s_waitcnt lgkmcnt(0)
s_add_u32 s20, s20, 0x9e3779b1
s_branch L_Wrest
L_roleA:
s_mov_b32 s8, s38
s_mov_b32 s9, s39
s_mov_b32 s10, 0x2000000
s_mov_b32 s11, 0x20000
v_lshlrev_b32 v5, 4, v1
v_xor_b32 v144, 0, v5
v_xor_b32 v145, 64, v5
v_xor_b32 v146, 128, v5
v_xor_b32 v147, 192, v5
v_xor_b32 v148, 16, v5
v_xor_b32 v149, 80, v5
v_xor_b32 v150, 144, v5
v_xor_b32 v151, 208, v5
v_xor_b32 v152, 32, v5
v_xor_b32 v153, 96, v5
v_xor_b32 v154, 160, v5
v_xor_b32 v155, 224, v5
v_xor_b32 v156, 48, v5
v_xor_b32 v157, 112, v5
v_xor_b32 v158, 176, v5
v_xor_b32 v159, 240, v5
v_lshrrev_b32 v3, 4, v0
v_and_b32 v4, 15, v0
s_cmp_ge_u32 s22, 100
s_cbranch_scc1 L_noP1a
s_mov_b32 s12, s56
s_mov_b32 s13, s57
s_mov_b32 s14, 0x4b0000
s_mov_b32 s15, 0x20000
s_mov_b32 s16, s54
s_mov_b32 s17, s55
s_mov_b32 s18, 0x500
s_mov_b32 s19, 0x20000
s_mul_i32 s96, s22, 205
s_lshr_b32 s96, s96, 11
s_mul_i32 s27, s96, 10
s_sub_u32 s97, s22, s27
v_lshlrev_b32 v6, 3, v3
s_lshl_b32 s27, s96, 7
buffer_load_dwordx2 v[40:41], v6, s[16:19], s27 offen
s_mov_b32 s16, s36
s_mov_b32 s17, s37
s_mov_b32 s18, 0x500
s_mov_b32 s19, 0x20000
v_mul_u32_u24 v7, 20, v1
buffer_load_dword v45, v7, s[16:19], 0 offen offset:0
buffer_load_dword v46, v7, s[16:19], 0 offen offset:4
buffer_load_dword v47, v7, s[16:19], 0 offen offset:8
buffer_load_dword v48, v7, s[16:19], 0 offen offset:12
buffer_load_dword v49, v7, s[16:19], 0 offen offset:16
v_and_b32 v9, 31, v0
v_lshlrev_b32 v9, 2, v9
s_lshl_b32 s27, s97, 7
buffer_load_dword v50, v9, s[16:19], s27 offen
s_mov_b32 s27, 30720
v_mul_lo_u32 v8, v3, s27
v_and_b32 v9, 7, v4
v_lshl_add_u32 v8, v9, 4, v8
v_lshrrev_b32 v9, 3, v4
v_mul_u32_u24 v9, 1280, v9
v_add_u32 v8, v8, v9
s_mul_i32 s27, s96, 491520
s_lshl_b32 s30, s97, 7
s_add_u32 s27, s27, s30
s_add_u32 s30, s27, 0
buffer_load_dwordx4 v[64:67], v8, s[12:15], s30 offen nt
s_add_u32 s30, s27, 7680
buffer_load_dwordx4 v[68:71], v8, s[12:15], s30 offen nt
s_add_u32 s30, s27, 15360
buffer_load_dwordx4 v[72:75], v8, s[12:15], s30 offen nt
s_add_u32 s30, s27, 23040
buffer_load_dwordx4 v[76:79], v8, s[12:15], s30 offen nt
L_noP1a:
s_lshl_b32 s94, s22, 18
s_lshl_b32 s95, s21, 15
s_add_u32 s94, s94, s95
s_add_u32 s34, s94, 0
s_add_u32 s35, s95, 0
s_mov_b32 m0, s35
s_nop 0
buffer_load_dwordx4 v144, s[8:11], s34 offen offset:0 nt lds
buffer_load_dwordx4 v145, s[8:11], s34 offen offset:1024 nt lds
buffer_load_dwordx4 v146, s[8:11], s34 offen offset:2048 nt lds
buffer_load_dwordx4 v147, s[8:11], s34 offen offset:3072 nt lds
s_add_u32 s34, s94, 4096
s_add_u32 s35, s95, 4096
s_mov_b32 m0, s35
s_nop 0
buffer_load_dwordx4 v148, s[8:11], s34 offen offset:0 nt lds
buffer_load_dwordx4 v149, s[8:11], s34 offen offset:1024 nt lds
s_cmp_ge_u32 s22, 100
s_cbranch_scc1 L_noP1b
s_waitcnt vmcnt(16)
v_lshlrev_b32 v52, 16, v40
v_and_b32 v53, 0xffff0000, v40
v_mul_f32 v54, 0xbfb8aa3b, v52
v_mul_f32 v55, 0xbfb8aa3b, v53
v_exp_f32 v54, v54
v_exp_f32 v55, v55
s_nop 0
v_add_f32 v54, 1.0, v54
v_add_f32 v55, 1.0, v55
v_rcp_f32 v54, v54
v_rcp_f32 v55, v55
s_nop 0
v_mul_f32 v52, v52, v54
v_mul_f32 v53, v53, v55
v_cvt_pk_bf16_f32 v40, v52, v53
v_lshlrev_b32 v52, 16, v41
v_and_b32 v53, 0xffff0000, v41
v_mul_f32 v54, 0xbfb8aa3b, v52
v_mul_f32 v55, 0xbfb8aa3b, v53
v_exp_f32 v54, v54
v_exp_f32 v55, v55
s_nop 0
v_add_f32 v54, 1.0, v54
v_add_f32 v55, 1.0, v55
v_rcp_f32 v54, v54
v_rcp_f32 v55, v55
s_nop 0
v_mul_f32 v52, v52, v54
v_mul_f32 v53, v53, v55
v_cvt_pk_bf16_f32 v41, v52, v53
s_waitcnt vmcnt(10)
v_lshlrev_b32 v20, 16, v45
v_and_b32 v21, 0xffff0000, v45
v_lshlrev_b32 v22, 16, v46
v_and_b32 v23, 0xffff0000, v46
v_lshlrev_b32 v24, 16, v47
v_and_b32 v25, 0xffff0000, v47
v_lshlrev_b32 v26, 16, v48
v_and_b32 v27, 0xffff0000, v48
v_lshlrev_b32 v28, 16, v49
v_and_b32 v29, 0xffff0000, v49
v_add_f32 v30, v20, v21
v_add_f32 v30, v30, v22
v_add_f32 v30, v30, v23
v_add_f32 v30, v30, v24
v_add_f32 v30, v30, v25
v_add_f32 v30, v30, v26
v_add_f32 v30, v30, v27
v_add_f32 v30, v30, v28
v_add_f32 v30, v30, v29
s_nop 1
v_add_f32_dpp v30, v30, v30 row_ror:8 row_mask:0xf bank_mask:0xf
s_nop 1
v_add_f32_dpp v30, v30, v30 row_ror:4 row_mask:0xf bank_mask:0xf
s_nop 1
v_add_f32_dpp v30, v30, v30 row_ror:2 row_mask:0xf bank_mask:0xf
s_nop 1
v_add_f32_dpp v30, v30, v30 row_ror:1 row_mask:0xf bank_mask:0xf
s_nop 0
v_mov_b32 v32, v30
s_nop 1
v_permlane16_swap_b32 v32, v30
s_nop 1
v_add_f32 v30, v32, v30
s_nop 0
v_mov_b32 v32, v30
s_nop 1
v_permlane32_swap_b32 v32, v30
s_nop 1
v_add_f32 v30, v32, v30
v_mul_f32 v30, 0x3acccccd, v30
v_sub_f32 v32, v20, v30
v_mul_f32 v31, v32, v32
v_sub_f32 v32, v21, v30
v_fmac_f32 v31, v32, v32
v_sub_f32 v32, v22, v30
v_fmac_f32 v31, v32, v32
v_sub_f32 v32, v23, v30
v_fmac_f32 v31, v32, v32
v_sub_f32 v32, v24, v30
v_fmac_f32 v31, v32, v32
v_sub_f32 v32, v25, v30
v_fmac_f32 v31, v32, v32
v_sub_f32 v32, v26, v30
v_fmac_f32 v31, v32, v32
v_sub_f32 v32, v27, v30
v_fmac_f32 v31, v32, v32
v_sub_f32 v32, v28, v30
v_fmac_f32 v31, v32, v32
v_sub_f32 v32, v29, v30
v_fmac_f32 v31, v32, v32
s_nop 1
v_add_f32_dpp v31, v31, v31 row_ror:8 row_mask:0xf bank_mask:0xf
s_nop 1
v_add_f32_dpp v31, v31, v31 row_ror:4 row_mask:0xf bank_mask:0xf
s_nop 1
v_add_f32_dpp v31, v31, v31 row_ror:2 row_mask:0xf bank_mask:0xf
s_nop 1
v_add_f32_dpp v31, v31, v31 row_ror:1 row_mask:0xf bank_mask:0xf
s_nop 0
v_mov_b32 v32, v31
s_nop 1
v_permlane16_swap_b32 v32, v31
s_nop 1
v_add_f32 v31, v32, v31
s_nop 0
v_mov_b32 v32, v31
s_nop 1
v_permlane32_swap_b32 v32, v31
s_nop 1
v_add_f32 v31, v32, v31
v_mov_b32 v32, 0x3727c5ac
v_fmac_f32 v32, 0x3acccccd, v31
v_rsq_f32 v31, v32
s_nop 0
buffer_load_dwordx4 v150, s[8:11], s34 offen offset:2048 nt lds
buffer_load_dwordx4 v151, s[8:11], s34 offen offset:3072 nt lds
s_add_u32 s34, s94, 8192
s_add_u32 s35, s95, 8192
s_mov_b32 m0, s35
s_nop 0
buffer_load_dwordx4 v152, s[8:11], s34 offen offset:0 nt lds
buffer_load_dwordx4 v153, s[8:11], s34 offen offset:1024 nt lds
buffer_load_dwordx4 v154, s[8:11], s34 offen offset:2048 nt lds
buffer_load_dwordx4 v155, s[8:11], s34 offen offset:3072 nt lds
s_waitcnt vmcnt(12)
v_perm_b32 v62, v68, v64, s24
v_perm_b32 v68, v68, v64, s25
v_mov_b32 v64, v62
v_perm_b32 v62, v69, v65, s24
v_perm_b32 v69, v69, v65, s25
v_mov_b32 v65, v62
v_perm_b32 v62, v70, v66, s24
v_perm_b32 v70, v70, v66, s25
v_mov_b32 v66, v62
v_perm_b32 v62, v71, v67, s24
v_perm_b32 v71, v71, v67, s25
v_mov_b32 v67, v62
v_perm_b32 v62, v76, v72, s24
v_perm_b32 v76, v76, v72, s25
v_mov_b32 v72, v62
v_perm_b32 v62, v77, v73, s24
v_perm_b32 v77, v77, v73, s25
v_mov_b32 v73, v62
v_perm_b32 v62, v78, v74, s24
v_perm_b32 v78, v78, v74, s25
v_mov_b32 v74, v62
v_perm_b32 v62, v79, v75, s24
v_perm_b32 v79, v79, v75, s25
v_mov_b32 v75, v62
v_mov_b32 v20, 0
v_mov_b32 v21, 0
v_mov_b32 v22, 0
v_mov_b32 v23, 0
v_mov_b32 v24, 0
v_mov_b32 v25, 0
v_mov_b32 v26, 0
v_mov_b32 v27, 0
v_dot2c_f32_bf16 v20, v64, v40
v_dot2c_f32_bf16 v21, v68, v40
v_dot2c_f32_bf16 v22, v65, v40
v_dot2c_f32_bf16 v23, v69, v40
v_dot2c_f32_bf16 v24, v66, v40
v_dot2c_f32_bf16 v25, v70, v40
v_dot2c_f32_bf16 v26, v67, v40
v_dot2c_f32_bf16 v27, v71, v40
v_dot2c_f32_bf16 v20, v72, v41
v_dot2c_f32_bf16 v21, v76, v41
v_dot2c_f32_bf16 v22, v73, v41
v_dot2c_f32_bf16 v23, v77, v41
v_dot2c_f32_bf16 v24, v74, v41
v_dot2c_f32_bf16 v25, v78, v41
v_dot2c_f32_bf16 v26, v75, v41
v_dot2c_f32_bf16 v27, v79, v41
s_nop 2
v_lshrrev_b32 v33, 4, v0
v_mul_u32_u24 v33, 512, v33
v_and_b32 v61, 15, v0
v_lshl_add_u32 v33, v61, 5, v33
v_add_u32 v33, 131072, v33
ds_write_b128 v33, v[20:23] offset:0
ds_write_b128 v33, v[24:27] offset:16
s_waitcnt lgkmcnt(0)
s_barrier
s_add_u32 s20, s20, 0x9e3779b1
v_cmp_gt_u32 vcc, 64, v0
s_and_saveexec_b64 s[28:29], vcc
s_cbranch_execz skip_1
v_and_b32 v33, 31, v0
v_lshlrev_b32 v33, 3, v33
v_lshrrev_b32 v34, 5, v0
v_lshl_add_u32 v33, v34, 8, v33
v_add_u32 v33, 131072, v33
ds_read_b64 v[64:65], v33 offset:0
ds_read_b64 v[66:67], v33 offset:512
ds_read_b64 v[68:69], v33 offset:1024
ds_read_b64 v[70:71], v33 offset:1536
ds_read_b64 v[72:73], v33 offset:2048
ds_read_b64 v[74:75], v33 offset:2560
ds_read_b64 v[76:77], v33 offset:3072
ds_read_b64 v[78:79], v33 offset:3584
ds_read_b64 v[80:81], v33 offset:4096
ds_read_b64 v[82:83], v33 offset:4608
ds_read_b64 v[84:85], v33 offset:5120
ds_read_b64 v[86:87], v33 offset:5632
ds_read_b64 v[88:89], v33 offset:6144
ds_read_b64 v[90:91], v33 offset:6656
ds_read_b64 v[92:93], v33 offset:7168
ds_read_b64 v[94:95], v33 offset:7680
s_waitcnt lgkmcnt(0)
v_pk_add_f32 v[64:65], v[64:65], v[80:81]
v_pk_add_f32 v[66:67], v[66:67], v[82:83]
v_pk_add_f32 v[68:69], v[68:69], v[84:85]
v_pk_add_f32 v[70:71], v[70:71], v[86:87]
v_pk_add_f32 v[72:73], v[72:73], v[88:89]
v_pk_add_f32 v[74:75], v[74:75], v[90:91]
v_pk_add_f32 v[76:77], v[76:77], v[92:93]
v_pk_add_f32 v[78:79], v[78:79], v[94:95]
v_pk_add_f32 v[64:65], v[64:65], v[72:73]
v_pk_add_f32 v[66:67], v[66:67], v[74:75]
v_pk_add_f32 v[68:69], v[68:69], v[76:77]
v_pk_add_f32 v[70:71], v[70:71], v[78:79]
v_pk_add_f32 v[64:65], v[64:65], v[68:69]
v_pk_add_f32 v[66:67], v[66:67], v[70:71]
v_pk_add_f32 v[64:65], v[64:65], v[66:67]
v_mov_b32 v40, v64
v_mov_b32 v41, v65
v_mov_b32 v42, v40
v_mov_b32 v43, v41
s_nop 1
v_permlane32_swap_b32 v40, v42
v_permlane32_swap_b32 v41, v43
s_nop 1
v_lshlrev_b32 v44, 16, v50
v_and_b32 v45, 0xffff0000, v50
s_cmp_eq_u32 s96, 0
s_cselect_b32 s27, 1.0, 0
v_sub_f32 v44, v44, v30
v_mul_f32 v44, v44, v31
v_add_f32 v42, s27, v42
v_fma_f32 v40, v44, v42, v40
v_sub_f32 v45, v45, v30
v_mul_f32 v45, v45, v31
v_add_f32 v43, s27, v43
v_fma_f32 v41, v45, v43, v41
v_mov_b32 v44, v40
v_mov_b32 v45, s20
v_mov_b32 v46, v41
v_mov_b32 v47, s20
s_mul_i32 s27, s96, 5120
s_lshl_b32 s30, s97, 9
s_add_u32 s27, s27, s30
s_add_u32 s27, s27, 4096
v_lshlrev_b32 v33, 4, v0
v_cmp_gt_u32 vcc, 32, v0
s_and_b64 exec, exec, vcc
buffer_store_dwordx4 v[44:47], v33, s[4:7], s27 offen sc1
skip_1:
s_mov_b64 exec, s[28:29]
s_branch L_P1done
L_noP1b:
buffer_load_dwordx4 v150, s[8:11], s34 offen offset:2048 nt lds
buffer_load_dwordx4 v151, s[8:11], s34 offen offset:3072 nt lds
s_add_u32 s34, s94, 8192
s_add_u32 s35, s95, 8192
s_mov_b32 m0, s35
s_nop 0
buffer_load_dwordx4 v152, s[8:11], s34 offen offset:0 nt lds
buffer_load_dwordx4 v153, s[8:11], s34 offen offset:1024 nt lds
buffer_load_dwordx4 v154, s[8:11], s34 offen offset:2048 nt lds
buffer_load_dwordx4 v155, s[8:11], s34 offen offset:3072 nt lds
s_waitcnt lgkmcnt(0)
s_add_u32 s20, s20, 0x9e3779b1
L_P1done:
s_add_u32 s34, s94, 12288
s_add_u32 s35, s95, 12288
s_mov_b32 m0, s35
s_nop 0
buffer_load_dwordx4 v156, s[8:11], s34 offen offset:0 nt lds
s_waitcnt vmcnt(8)
buffer_load_dwordx4 v157, s[8:11], s34 offen offset:1024 nt lds
s_waitcnt vmcnt(8)
buffer_load_dwordx4 v158, s[8:11], s34 offen offset:2048 nt lds
s_waitcnt vmcnt(8)
buffer_load_dwordx4 v159, s[8:11], s34 offen offset:3072 nt lds
s_waitcnt vmcnt(8)
s_add_u32 s34, s94, 16384
s_add_u32 s35, s95, 16384
s_mov_b32 m0, s35
s_nop 0
buffer_load_dwordx4 v144, s[8:11], s34 offen offset:0 nt lds
s_waitcnt vmcnt(8)
buffer_load_dwordx4 v145, s[8:11], s34 offen offset:1024 nt lds
s_waitcnt vmcnt(8)
buffer_load_dwordx4 v146, s[8:11], s34 offen offset:2048 nt lds
s_waitcnt vmcnt(8)
buffer_load_dwordx4 v147, s[8:11], s34 offen offset:3072 nt lds
s_waitcnt vmcnt(8)
s_add_u32 s34, s94, 20480
s_add_u32 s35, s95, 20480
s_mov_b32 m0, s35
s_nop 0
buffer_load_dwordx4 v148, s[8:11], s34 offen offset:0 nt lds
s_waitcnt vmcnt(8)
buffer_load_dwordx4 v149, s[8:11], s34 offen offset:1024 nt lds
s_waitcnt vmcnt(8)
buffer_load_dwordx4 v150, s[8:11], s34 offen offset:2048 nt lds
s_waitcnt vmcnt(8)
buffer_load_dwordx4 v151, s[8:11], s34 offen offset:3072 nt lds
s_waitcnt vmcnt(8)
s_add_u32 s34, s94, 24576
s_add_u32 s35, s95, 24576
s_mov_b32 m0, s35
s_nop 0
buffer_load_dwordx4 v152, s[8:11], s34 offen offset:0 nt lds
s_waitcnt vmcnt(8)
buffer_load_dwordx4 v153, s[8:11], s34 offen offset:1024 nt lds
s_waitcnt vmcnt(8)
buffer_load_dwordx4 v154, s[8:11], s34 offen offset:2048 nt lds
s_waitcnt vmcnt(8)
buffer_load_dwordx4 v155, s[8:11], s34 offen offset:3072 nt lds
s_waitcnt vmcnt(8)
s_add_u32 s34, s94, 28672
s_add_u32 s35, s95, 28672
s_mov_b32 m0, s35
s_nop 0
buffer_load_dwordx4 v156, s[8:11], s34 offen offset:0 nt lds
s_waitcnt vmcnt(8)
buffer_load_dwordx4 v157, s[8:11], s34 offen offset:1024 nt lds
s_waitcnt vmcnt(8)
buffer_load_dwordx4 v158, s[8:11], s34 offen offset:2048 nt lds
s_waitcnt vmcnt(8)
buffer_load_dwordx4 v159, s[8:11], s34 offen offset:3072 nt lds
s_waitcnt vmcnt(8)
s_lshl_b32 s27, s22, 18
s_lshl_b32 s30, s21, 13
s_add_u32 s27, s27, s30
s_add_u32 s93, s27, 131072
s_and_b32 s30, s21, 1
s_lshl_b32 s30, s30, 5
v_xor_b32 v176, s30, v144
v_xor_b32 v177, s30, v145
v_xor_b32 v178, s30, v146
v_xor_b32 v179, s30, v147
v_xor_b32 v180, s30, v148
v_xor_b32 v181, s30, v149
v_xor_b32 v182, s30, v150
v_xor_b32 v183, s30, v151
s_add_u32 s34, s93, 0
buffer_load_dwordx4 a[0:3], v176, s[8:11], s34 offen offset:0 nt
s_waitcnt vmcnt(8)
buffer_load_dwordx4 a[4:7], v177, s[8:11], s34 offen offset:1024 nt
s_waitcnt vmcnt(8)
buffer_load_dwordx4 a[8:11], v178, s[8:11], s34 offen offset:2048 nt
s_waitcnt vmcnt(8)
buffer_load_dwordx4 a[12:15], v179, s[8:11], s34 offen offset:3072 nt
s_waitcnt vmcnt(8)
s_add_u32 s34, s93, 4096
buffer_load_dwordx4 a[16:19], v180, s[8:11], s34 offen offset:0 nt
s_waitcnt vmcnt(8)
buffer_load_dwordx4 a[20:23], v181, s[8:11], s34 offen offset:1024 nt
s_waitcnt vmcnt(8)
buffer_load_dwordx4 a[24:27], v182, s[8:11], s34 offen offset:2048 nt
s_waitcnt vmcnt(8)
buffer_load_dwordx4 a[28:31], v183, s[8:11], s34 offen offset:3072 nt
s_waitcnt vmcnt(8)
s_add_u32 s34, s93, 32768
buffer_load_dwordx4 a[32:35], v176, s[8:11], s34 offen offset:0 nt
s_waitcnt vmcnt(8)
buffer_load_dwordx4 a[36:39], v177, s[8:11], s34 offen offset:1024 nt
s_waitcnt vmcnt(8)
buffer_load_dwordx4 a[40:43], v178, s[8:11], s34 offen offset:2048 nt
s_waitcnt vmcnt(8)
buffer_load_dwordx4 a[44:47], v179, s[8:11], s34 offen offset:3072 nt
s_waitcnt vmcnt(8)
s_add_u32 s34, s93, 36864
buffer_load_dwordx4 a[48:51], v180, s[8:11], s34 offen offset:0 nt
s_waitcnt vmcnt(8)
buffer_load_dwordx4 a[52:55], v181, s[8:11], s34 offen offset:1024 nt
s_waitcnt vmcnt(8)
buffer_load_dwordx4 a[56:59], v182, s[8:11], s34 offen offset:2048 nt
s_waitcnt vmcnt(8)
buffer_load_dwordx4 a[60:63], v183, s[8:11], s34 offen offset:3072 nt
s_waitcnt vmcnt(8)
v_and_b32 v6, 31, v1
v_lshrrev_b32 v7, 5, v1
v_and_b32 v8, 3, v1
v_lshlrev_b32 v8, 2, v8
v_bfe_u32 v9, v1, 2, 2
v_or_b32 v8, v8, v9
v_or_b32 v9, 0, v7
v_xor_b32 v9, v9, v8
v_lshlrev_b32 v9, 4, v9
v_lshl_add_u32 v160, v6, 10, v9
v_add_u32 v160, 131072, v160
v_or_b32 v9, 2, v7
v_xor_b32 v9, v9, v8
v_lshlrev_b32 v9, 4, v9
v_lshl_add_u32 v161, v6, 10, v9
v_add_u32 v161, 131072, v161
v_or_b32 v9, 4, v7
v_xor_b32 v9, v9, v8
v_lshlrev_b32 v9, 4, v9
v_lshl_add_u32 v162, v6, 10, v9
v_add_u32 v162, 131072, v162
v_or_b32 v9, 6, v7
v_xor_b32 v9, v9, v8
v_lshlrev_b32 v9, 4, v9
v_lshl_add_u32 v163, v6, 10, v9
v_add_u32 v163, 131072, v163
v_or_b32 v9, 8, v7
v_xor_b32 v9, v9, v8
v_lshlrev_b32 v9, 4, v9
v_lshl_add_u32 v164, v6, 10, v9
v_add_u32 v164, 131072, v164
v_or_b32 v9, 10, v7
v_xor_b32 v9, v9, v8
v_lshlrev_b32 v9, 4, v9
v_lshl_add_u32 v165, v6, 10, v9
v_add_u32 v165, 131072, v165
v_or_b32 v9, 12, v7
v_xor_b32 v9, v9, v8
v_lshlrev_b32 v9, 4, v9
v_lshl_add_u32 v166, v6, 10, v9
v_add_u32 v166, 131072, v166
v_or_b32 v9, 14, v7
v_xor_b32 v9, v9, v8
v_lshlrev_b32 v9, 4, v9
v_lshl_add_u32 v167, v6, 10, v9
v_add_u32 v167, 131072, v167
v_bfe_u32 v9, v1, 2, 2
v_bfe_u32 v10, v1, 4, 1
v_bfe_u32 v11, v1, 1, 1
v_lshl_or_b32 v10, v10, 1, v11
v_lshl_add_u32 v11, v7, 2, v9
v_lshlrev_b32 v11, 10, v11
v_and_b32 v12, 1, v1
v_lshl_add_u32 v11, v12, 3, v11
s_lshl_b32 s27, s21, 8
v_add_u32 v11, s27, v11
v_xor_b32 v12, 0, v9
v_lshlrev_b32 v12, 2, v12
v_or_b32 v13, 0, v7
v_xor_b32 v13, v13, v10
v_or_b32 v12, v12, v13
v_lshl_add_u32 v168, v12, 4, v11
v_xor_b32 v12, 0, v9
v_lshlrev_b32 v12, 2, v12
v_or_b32 v13, 2, v7
v_xor_b32 v13, v13, v10
v_or_b32 v12, v12, v13
v_lshl_add_u32 v169, v12, 4, v11
v_xor_b32 v12, 1, v9
v_lshlrev_b32 v12, 2, v12
v_or_b32 v13, 0, v7
v_xor_b32 v13, v13, v10
v_or_b32 v12, v12, v13
v_lshl_add_u32 v170, v12, 4, v11
v_xor_b32 v12, 1, v9
v_lshlrev_b32 v12, 2, v12
v_or_b32 v13, 2, v7
v_xor_b32 v13, v13, v10
v_or_b32 v12, v12, v13
v_lshl_add_u32 v171, v12, 4, v11
v_xor_b32 v12, 2, v9
v_lshlrev_b32 v12, 2, v12
v_or_b32 v13, 0, v7
v_xor_b32 v13, v13, v10
v_or_b32 v12, v12, v13
v_lshl_add_u32 v172, v12, 4, v11
v_xor_b32 v12, 2, v9
v_lshlrev_b32 v12, 2, v12
v_or_b32 v13, 2, v7
v_xor_b32 v13, v13, v10
v_or_b32 v12, v12, v13
v_lshl_add_u32 v173, v12, 4, v11
v_xor_b32 v12, 3, v9
v_lshlrev_b32 v12, 2, v12
v_or_b32 v13, 0, v7
v_xor_b32 v13, v13, v10
v_or_b32 v12, v12, v13
v_lshl_add_u32 v174, v12, 4, v11
v_xor_b32 v12, 3, v9
v_lshlrev_b32 v12, 2, v12
v_or_b32 v13, 2, v7
v_xor_b32 v13, v13, v10
v_or_b32 v12, v12, v13
v_lshl_add_u32 v175, v12, 4, v11
s_lshl_b32 s27, s21, 15
s_sub_u32 s27, s27, 131072
v_add_u32 v184, s27, v160
v_add_u32 v185, s27, v161
v_add_u32 v186, s27, v162
v_add_u32 v187, s27, v163
v_add_u32 v188, s27, v164
v_add_u32 v189, s27, v165
v_add_u32 v190, s27, v166
v_add_u32 v191, s27, v167
v_mov_b32 v16, 0
v_mov_b32 v17, 0
v_mov_b32 v18, 0
v_mov_b32 v19, 0
v_mov_b32 v20, 0
v_mov_b32 v21, 0
v_mov_b32 v22, 0
v_mov_b32 v23, 0
v_mov_b32 v24, 0
v_mov_b32 v25, 0
v_mov_b32 v26, 0
v_mov_b32 v27, 0
v_mov_b32 v28, 0
v_mov_b32 v29, 0
v_mov_b32 v30, 0
v_mov_b32 v31, 0
v_mov_b32 v32, 0
v_mov_b32 v33, 0
v_mov_b32 v34, 0
v_mov_b32 v35, 0
v_mov_b32 v36, 0
v_mov_b32 v37, 0
v_mov_b32 v38, 0
v_mov_b32 v39, 0
v_mov_b32 v40, 0
v_mov_b32 v41, 0
v_mov_b32 v42, 0
v_mov_b32 v43, 0
v_mov_b32 v44, 0
v_mov_b32 v45, 0
v_mov_b32 v46, 0
v_mov_b32 v47, 0
v_mov_b32 v48, 0
v_mov_b32 v49, 0
v_mov_b32 v50, 0
v_mov_b32 v51, 0
v_mov_b32 v52, 0
v_mov_b32 v53, 0
v_mov_b32 v54, 0
v_mov_b32 v55, 0
v_mov_b32 v56, 0
v_mov_b32 v57, 0
v_mov_b32 v58, 0
v_mov_b32 v59, 0
v_mov_b32 v62, 0
v_mov_b32 v63, 0
s_waitcnt vmcnt(0)
s_lshl_b32 s27, s21, 14
s_add_u32 s27, s27, 262144
s_add_u32 s84, s27, 0
s_add_u32 s85, s27, 2048
s_add_u32 s86, s27, 4096
s_add_u32 s87, s27, 6144
s_add_u32 s88, s27, 8192
s_add_u32 s89, s27, 10240
s_add_u32 s90, s27, 12288
s_add_u32 s91, s27, 14336
s_mov_b32 s26, 100000
g_2:
buffer_load_dwordx4 v[64:67], v5, s[4:7], s84 offen offset:0 sc1
buffer_load_dwordx4 v[68:71], v5, s[4:7], s84 offen offset:1024 sc1
buffer_load_dwordx4 v[72:75], v5, s[4:7], s85 offen offset:0 sc1
buffer_load_dwordx4 v[76:79], v5, s[4:7], s85 offen offset:1024 sc1
buffer_load_dwordx4 v[80:83], v5, s[4:7], s86 offen offset:0 sc1
buffer_load_dwordx4 v[84:87], v5, s[4:7], s86 offen offset:1024 sc1
buffer_load_dwordx4 v[88:91], v5, s[4:7], s87 offen offset:0 sc1
buffer_load_dwordx4 v[92:95], v5, s[4:7], s87 offen offset:1024 sc1
buffer_load_dwordx4 v[96:99], v5, s[4:7], s88 offen offset:0 sc1
buffer_load_dwordx4 v[100:103], v5, s[4:7], s88 offen offset:1024 sc1
buffer_load_dwordx4 v[104:107], v5, s[4:7], s89 offen offset:0 sc1
buffer_load_dwordx4 v[108:111], v5, s[4:7], s89 offen offset:1024 sc1
buffer_load_dwordx4 v[112:115], v5, s[4:7], s90 offen offset:0 sc1
buffer_load_dwordx4 v[116:119], v5, s[4:7], s90 offen offset:1024 sc1
buffer_load_dwordx4 v[120:123], v5, s[4:7], s91 offen offset:0 sc1
buffer_load_dwordx4 v[124:127], v5, s[4:7], s91 offen offset:1024 sc1
s_waitcnt vmcnt(0)
v_xor_b32 v60, s20, v65
v_xor_b32 v61, s20, v67
v_or_b32 v60, v60, v61
v_xor_b32 v61, s20, v69
v_or_b32 v60, v60, v61
v_xor_b32 v61, s20, v71
v_or_b32 v60, v60, v61
v_xor_b32 v61, s20, v73
v_or_b32 v60, v60, v61
v_xor_b32 v61, s20, v75
v_or_b32 v60, v60, v61
v_xor_b32 v61, s20, v77
v_or_b32 v60, v60, v61
v_xor_b32 v61, s20, v79
v_or_b32 v60, v60, v61
v_xor_b32 v61, s20, v81
v_or_b32 v60, v60, v61
v_xor_b32 v61, s20, v83
v_or_b32 v60, v60, v61
v_xor_b32 v61, s20, v85
v_or_b32 v60, v60, v61
v_xor_b32 v61, s20, v87
v_or_b32 v60, v60, v61
v_xor_b32 v61, s20, v89
v_or_b32 v60, v60, v61
v_xor_b32 v61, s20, v91
v_or_b32 v60, v60, v61
v_xor_b32 v61, s20, v93
v_or_b32 v60, v60, v61
v_xor_b32 v61, s20, v95
v_or_b32 v60, v60, v61
v_xor_b32 v61, s20, v97
v_or_b32 v60, v60, v61
v_xor_b32 v61, s20, v99
v_or_b32 v60, v60, v61
v_xor_b32 v61, s20, v101
v_or_b32 v60, v60, v61
v_xor_b32 v61, s20, v103
v_or_b32 v60, v60, v61
v_xor_b32 v61, s20, v105
v_or_b32 v60, v60, v61
v_xor_b32 v61, s20, v107
v_or_b32 v60, v60, v61
v_xor_b32 v61, s20, v109
v_or_b32 v60, v60, v61
v_xor_b32 v61, s20, v111
v_or_b32 v60, v60, v61
v_xor_b32 v61, s20, v113
v_or_b32 v60, v60, v61
v_xor_b32 v61, s20, v115
v_or_b32 v60, v60, v61
v_xor_b32 v61, s20, v117
v_or_b32 v60, v60, v61
v_xor_b32 v61, s20, v119
v_or_b32 v60, v60, v61
v_xor_b32 v61, s20, v121
v_or_b32 v60, v60, v61
v_xor_b32 v61, s20, v123
v_or_b32 v60, v60, v61
v_xor_b32 v61, s20, v125
v_or_b32 v60, v60, v61
v_xor_b32 v61, s20, v127
v_or_b32 v60, v60, v61
v_cmp_ne_u32 vcc, 0, v60
s_cbranch_vccz gd_3
s_sub_u32 s26, s26, 1
s_cmp_eq_u32 s26, 0
s_cbranch_scc1 gd_3
s_sleep 3
s_branch g_2
gd_3:
s_add_u32 s34, s93, 65536
buffer_load_dwordx4 a[64:67], v176, s[8:11], s34 offen offset:0 nt
buffer_load_dwordx4 a[68:71], v177, s[8:11], s34 offen offset:1024 nt
buffer_load_dwordx4 a[72:75], v178, s[8:11], s34 offen offset:2048 nt
buffer_load_dwordx4 a[76:79], v179, s[8:11], s34 offen offset:3072 nt
s_add_u32 s34, s93, 69632
buffer_load_dwordx4 a[80:83], v180, s[8:11], s34 offen offset:0 nt
buffer_load_dwordx4 a[84:87], v181, s[8:11], s34 offen offset:1024 nt
buffer_load_dwordx4 a[88:91], v182, s[8:11], s34 offen offset:2048 nt
buffer_load_dwordx4 a[92:95], v183, s[8:11], s34 offen offset:3072 nt
s_add_u32 s34, s93, 98304
buffer_load_dwordx4 a[96:99], v176, s[8:11], s34 offen offset:0 nt
buffer_load_dwordx4 a[100:103], v177, s[8:11], s34 offen offset:1024 nt
buffer_load_dwordx4 a[104:107], v178, s[8:11], s34 offen offset:2048 nt
buffer_load_dwordx4 a[108:111], v179, s[8:11], s34 offen offset:3072 nt
s_add_u32 s34, s93, 102400
buffer_load_dwordx4 a[112:115], v180, s[8:11], s34 offen offset:0 nt
buffer_load_dwordx4 a[116:119], v181, s[8:11], s34 offen offset:1024 nt
buffer_load_dwordx4 a[120:123], v182, s[8:11], s34 offen offset:2048 nt
buffer_load_dwordx4 a[124:127], v183, s[8:11], s34 offen offset:3072 nt
v_lshrrev_b32 v9, 1, v1
v_lshlrev_b32 v9, 4, v9
s_and_b32 s27, s21, 1
s_lshl_b32 s27, s27, 5
v_xor_b32 v9, s27, v9
v_and_b32 v10, 1, v1
v_lshl_add_u32 v9, v10, 3, v9
s_lshl_b32 s27, s21, 13
s_add_u32 s27, s27, 131072
v_add_u32 v9, s27, v9
v_xor_b32 v10, 0, v9
v_add_u32 v11, 0, v10
ds_write2_b32 v11, v64, v66 offset0:0 offset1:1
v_add_u32 v11, 512, v10
ds_write2_b32 v11, v68, v70 offset0:0 offset1:1
v_xor_b32 v10, 64, v9
v_add_u32 v11, 1024, v10
ds_write2_b32 v11, v72, v74 offset0:0 offset1:1
v_add_u32 v11, 1536, v10
ds_write2_b32 v11, v76, v78 offset0:0 offset1:1
v_xor_b32 v10, 128, v9
v_add_u32 v11, 2048, v10
ds_write2_b32 v11, v80, v82 offset0:0 offset1:1
v_add_u32 v11, 2560, v10
ds_write2_b32 v11, v84, v86 offset0:0 offset1:1
v_xor_b32 v10, 192, v9
v_add_u32 v11, 3072, v10
ds_write2_b32 v11, v88, v90 offset0:0 offset1:1
v_add_u32 v11, 3584, v10
ds_write2_b32 v11, v92, v94 offset0:0 offset1:1
v_xor_b32 v10, 16, v9
v_add_u32 v11, 4096, v10
ds_write2_b32 v11, v96, v98 offset0:0 offset1:1
v_add_u32 v11, 4608, v10
ds_write2_b32 v11, v100, v102 offset0:0 offset1:1
v_xor_b32 v10, 80, v9
v_add_u32 v11, 5120, v10
ds_write2_b32 v11, v104, v106 offset0:0 offset1:1
v_add_u32 v11, 5632, v10
ds_write2_b32 v11, v108, v110 offset0:0 offset1:1
v_xor_b32 v10, 144, v9
v_add_u32 v11, 6144, v10
ds_write2_b32 v11, v112, v114 offset0:0 offset1:1
v_add_u32 v11, 6656, v10
ds_write2_b32 v11, v116, v118 offset0:0 offset1:1
v_xor_b32 v10, 208, v9
v_add_u32 v11, 7168, v10
ds_write2_b32 v11, v120, v122 offset0:0 offset1:1
v_add_u32 v11, 7680, v10
ds_write2_b32 v11, v124, v126 offset0:0 offset1:1
v_mov_b32 v60, 0
v_mov_b32 v61, 0
v_mov_b32 v64, 0
v_mov_b32 v65, 0
v_mov_b32 v66, 0
v_mov_b32 v67, 0
v_mov_b32 v68, 0
v_mov_b32 v69, 0
v_mov_b32 v70, 0
v_mov_b32 v71, 0
v_mov_b32 v72, 0
v_mov_b32 v73, 0
v_mov_b32 v74, 0
v_mov_b32 v75, 0
v_mov_b32 v76, 0
v_mov_b32 v77, 0
v_mov_b32 v78, 0
v_mov_b32 v79, 0
v_mov_b32 v8, 0xff800000
v_mov_b32 v9, 0
v_mov_b32 v2, 0
v_lshlrev_b32 v10, 2, v6
v_add_u32 v10, 139264, v10
s_lshl_b32 s27, s21, 7
v_add_u32 v11, s27, v10
s_lshl_b32 s27, s21, 11
s_add_u32 s27, s27, 131072
v_add_u32 v12, s27, v5
v_add_u32 v13, 131072, v5
s_lshl_b32 s27, s21, 13
v_add_u32 v4, s27, v5
v_add_u32 v3, 0x10000, v4
v_mov_b32 v14, 0
v_mov_b32 v15, 0
s_waitcnt lgkmcnt(0)
s_barrier
ds_read_b128 a[128:131], v160 offset:0
ds_read_b128 v[96:99], v184 offset:0
ds_read_b128 a[132:135], v161 offset:0
ds_read_b128 v[100:103], v185 offset:0
ds_read_b128 a[136:139], v162 offset:0
ds_read_b128 v[104:107], v186 offset:0
ds_read_b128 a[140:143], v163 offset:0
ds_read_b128 v[108:111], v187 offset:0
ds_read_b128 a[144:147], v164 offset:0
ds_read_b128 v[112:115], v188 offset:0
ds_read_b128 a[148:151], v165 offset:0
ds_read_b128 v[116:119], v189 offset:0
s_waitcnt lgkmcnt(10)
v_mfma_f32_32x32x16_bf16 v[80:95], v[96:99], a[128:131], 0
ds_read_b128 a[152:155], v166 offset:0
ds_read_b128 v[120:123], v190 offset:0
s_waitcnt lgkmcnt(10)
v_mfma_f32_32x32x16_bf16 v[80:95], v[100:103], a[132:135], v[80:95]
ds_read_b128 a[156:159], v167 offset:0
ds_read_b128 v[124:127], v191 offset:0
s_waitcnt lgkmcnt(10)
v_mfma_f32_32x32x16_bf16 v[80:95], v[104:107], a[136:139], v[80:95]
ds_read_b128 a[160:163], v160 offset:256
ds_read_b128 v[96:99], v184 offset:256
s_waitcnt lgkmcnt(10)
v_mfma_f32_32x32x16_bf16 v[80:95], v[108:111], a[140:143], v[80:95]
ds_read_b128 a[164:167], v161 offset:256
ds_read_b128 v[100:103], v185 offset:256
s_waitcnt lgkmcnt(10)
v_mfma_f32_32x32x16_bf16 v[80:95], v[112:115], a[144:147], v[80:95]
ds_read_b128 a[168:171], v162 offset:256
ds_read_b128 v[104:107], v186 offset:256
s_waitcnt lgkmcnt(10)
v_mfma_f32_32x32x16_bf16 v[80:95], v[116:119], a[148:151], v[80:95]
ds_read_b128 a[172:175], v163 offset:256
ds_read_b128 v[108:111], v187 offset:256
s_waitcnt lgkmcnt(10)
v_mfma_f32_32x32x16_bf16 v[80:95], v[120:123], a[152:155], v[80:95]
ds_read_b128 a[176:179], v164 offset:256
ds_read_b128 v[112:115], v188 offset:256
s_waitcnt lgkmcnt(10)
v_mfma_f32_32x32x16_bf16 v[80:95], v[124:127], a[156:159], v[80:95]
ds_read_b128 a[180:183], v165 offset:256
ds_read_b128 v[116:119], v189 offset:256
s_waitcnt lgkmcnt(10)
v_mfma_f32_32x32x16_bf16 v[80:95], v[96:99], a[160:163], v[80:95]
ds_read_b128 a[184:187], v166 offset:256
ds_read_b128 v[120:123], v190 offset:256
s_waitcnt lgkmcnt(10)
v_mfma_f32_32x32x16_bf16 v[80:95], v[100:103], a[164:167], v[80:95]
ds_read_b128 a[188:191], v167 offset:256
ds_read_b128 v[124:127], v191 offset:256
s_waitcnt lgkmcnt(10)
v_mfma_f32_32x32x16_bf16 v[80:95], v[104:107], a[168:171], v[80:95]
ds_read_b128 a[192:195], v160 offset:512
ds_read_b128 v[96:99], v184 offset:512
s_waitcnt lgkmcnt(10)
v_mfma_f32_32x32x16_bf16 v[80:95], v[108:111], a[172:175], v[80:95]
ds_read_b128 a[196:199], v161 offset:512
ds_read_b128 v[100:103], v185 offset:512
s_waitcnt lgkmcnt(10)
v_mfma_f32_32x32x16_bf16 v[80:95], v[112:115], a[176:179], v[80:95]
ds_read_b128 a[200:203], v162 offset:512
ds_read_b128 v[104:107], v186 offset:512
s_waitcnt lgkmcnt(10)
v_mfma_f32_32x32x16_bf16 v[80:95], v[116:119], a[180:183], v[80:95]
ds_read_b128 a[204:207], v163 offset:512
ds_read_b128 v[108:111], v187 offset:512
s_waitcnt lgkmcnt(10)
v_mfma_f32_32x32x16_bf16 v[80:95], v[120:123], a[184:187], v[80:95]
ds_read_b128 a[208:211], v164 offset:512
ds_read_b128 v[112:115], v188 offset:512
s_waitcnt lgkmcnt(10)
v_mfma_f32_32x32x16_bf16 v[80:95], v[124:127], a[188:191], v[80:95]
ds_read_b128 a[212:215], v165 offset:512
ds_read_b128 v[116:119], v189 offset:512
s_waitcnt lgkmcnt(10)
v_mfma_f32_32x32x16_bf16 v[80:95], v[96:99], a[192:195], v[80:95]
ds_read_b128 a[216:219], v166 offset:512
ds_read_b128 v[120:123], v190 offset:512
s_waitcnt lgkmcnt(10)
v_mfma_f32_32x32x16_bf16 v[80:95], v[100:103], a[196:199], v[80:95]
ds_read_b128 a[220:223], v167 offset:512
ds_read_b128 v[124:127], v191 offset:512
s_waitcnt lgkmcnt(10)
v_mfma_f32_32x32x16_bf16 v[80:95], v[104:107], a[200:203], v[80:95]
ds_read_b128 a[224:227], v160 offset:768
ds_read_b128 v[96:99], v184 offset:768
s_waitcnt lgkmcnt(10)
v_mfma_f32_32x32x16_bf16 v[80:95], v[108:111], a[204:207], v[80:95]
ds_read_b128 a[228:231], v161 offset:768
ds_read_b128 v[100:103], v185 offset:768
s_waitcnt lgkmcnt(10)
v_mfma_f32_32x32x16_bf16 v[80:95], v[112:115], a[208:211], v[80:95]
ds_read_b128 a[232:235], v162 offset:768
ds_read_b128 v[104:107], v186 offset:768
s_waitcnt lgkmcnt(10)
v_mfma_f32_32x32x16_bf16 v[80:95], v[116:119], a[212:215], v[80:95]
ds_read_b128 a[236:239], v163 offset:768
ds_read_b128 v[108:111], v187 offset:768
s_waitcnt lgkmcnt(10)
v_mfma_f32_32x32x16_bf16 v[80:95], v[120:123], a[216:219], v[80:95]
ds_read_b128 a[240:243], v164 offset:768
ds_read_b128 v[112:115], v188 offset:768
s_waitcnt lgkmcnt(10)
v_mfma_f32_32x32x16_bf16 v[80:95], v[124:127], a[220:223], v[80:95]
ds_read_b128 a[244:247], v165 offset:768
ds_read_b128 v[116:119], v189 offset:768
s_waitcnt lgkmcnt(10)
v_mfma_f32_32x32x16_bf16 v[80:95], v[96:99], a[224:227], v[80:95]
ds_read_b128 a[248:251], v166 offset:768
ds_read_b128 v[120:123], v190 offset:768
s_waitcnt lgkmcnt(10)
v_mfma_f32_32x32x16_bf16 v[80:95], v[100:103], a[228:231], v[80:95]
ds_read_b128 a[252:255], v167 offset:768
ds_read_b128 v[124:127], v191 offset:768
s_waitcnt lgkmcnt(10)
v_mfma_f32_32x32x16_bf16 v[80:95], v[104:107], a[232:235], v[80:95]
s_waitcnt lgkmcnt(8)
v_mfma_f32_32x32x16_bf16 v[80:95], v[108:111], a[236:239], v[80:95]
s_waitcnt lgkmcnt(6)
v_mfma_f32_32x32x16_bf16 v[80:95], v[112:115], a[240:243], v[80:95]
s_waitcnt lgkmcnt(4)
v_mfma_f32_32x32x16_bf16 v[80:95], v[116:119], a[244:247], v[80:95]
s_waitcnt lgkmcnt(2)
v_mfma_f32_32x32x16_bf16 v[80:95], v[120:123], a[248:251], v[80:95]
s_waitcnt lgkmcnt(0)
v_mfma_f32_32x32x16_bf16 v[80:95], v[124:127], a[252:255], v[80:95]
s_nop 11
s_nop 3
v_max3_f32 v96, v80, v81, v82
v_max3_f32 v97, v83, v84, v85
v_max3_f32 v98, v86, v87, v88
v_max3_f32 v99, v89, v90, v91
v_max3_f32 v96, v96, v92, v93
v_max3_f32 v97, v97, v94, v95
v_max3_f32 v96, v96, v97, v98
v_max_f32 v96, v96, v99
v_mov_b32 v97, v96
s_nop 1
v_permlane32_swap_b32 v97, v96
s_nop 1
v_max_f32 v96, v96, v97
s_barrier
ds_write_b32 v11, v96
s_waitcnt lgkmcnt(0)
s_barrier
ds_read_b32 v96, v10
ds_read_b32 v97, v10 offset:128
ds_read_b32 v98, v10 offset:256
ds_read_b32 v99, v10 offset:384
ds_read_b64_tr_b16 v[104:105], v168 offset:0
ds_read_b64_tr_b16 v[106:107], v169 offset:8192
ds_read_b64_tr_b16 v[108:109], v170 offset:0
ds_read_b64_tr_b16 v[110:111], v171 offset:8192
ds_read_b64_tr_b16 v[112:113], v172 offset:0
ds_read_b64_tr_b16 v[114:115], v173 offset:8192
ds_read_b64_tr_b16 v[116:117], v174 offset:0
ds_read_b64_tr_b16 v[118:119], v175 offset:8192
s_waitcnt lgkmcnt(8)
v_max3_f32 v96, v96, v97, v98
v_max3_f32 v96, v96, v99, v8
v_mov_b32 v8, v96
v_sub_f32 v100, 0, v96
v_sub_f32 v101, 0, v96
v_pk_add_f32 v[80:81], v[80:81], v[100:101]
v_pk_add_f32 v[82:83], v[82:83], v[100:101]
v_pk_add_f32 v[84:85], v[84:85], v[100:101]
v_pk_add_f32 v[86:87], v[86:87], v[100:101]
v_pk_add_f32 v[88:89], v[88:89], v[100:101]
v_pk_add_f32 v[90:91], v[90:91], v[100:101]
v_pk_add_f32 v[92:93], v[92:93], v[100:101]
v_pk_add_f32 v[94:95], v[94:95], v[100:101]
v_exp_f32 v80, v80
v_exp_f32 v81, v81
v_exp_f32 v82, v82
v_exp_f32 v83, v83
v_exp_f32 v84, v84
v_exp_f32 v85, v85
v_exp_f32 v86, v86
v_exp_f32 v87, v87
v_exp_f32 v88, v88
v_exp_f32 v89, v89
v_exp_f32 v90, v90
v_exp_f32 v91, v91
v_exp_f32 v92, v92
v_exp_f32 v93, v93
v_exp_f32 v94, v94
v_exp_f32 v95, v95
s_nop 0
v_cvt_pk_bf16_f32 v96, v80, v81
v_cvt_pk_bf16_f32 v97, v82, v83
v_cvt_pk_bf16_f32 v98, v84, v85
v_cvt_pk_bf16_f32 v99, v86, v87
v_cvt_pk_bf16_f32 v100, v88, v89
v_cvt_pk_bf16_f32 v101, v90, v91
v_cvt_pk_bf16_f32 v102, v92, v93
v_cvt_pk_bf16_f32 v103, v94, v95
ds_write_b128 v12, v[96:99]
ds_write_b128 v12, v[100:103] offset:1024
v_pk_add_f32 v[14:15], v[14:15], v[80:81]
v_pk_add_f32 v[14:15], v[14:15], v[82:83]
v_pk_add_f32 v[14:15], v[14:15], v[84:85]
v_pk_add_f32 v[14:15], v[14:15], v[86:87]
v_pk_add_f32 v[14:15], v[14:15], v[88:89]
v_pk_add_f32 v[14:15], v[14:15], v[90:91]
v_pk_add_f32 v[14:15], v[14:15], v[92:93]
v_pk_add_f32 v[14:15], v[14:15], v[94:95]
s_waitcnt lgkmcnt(0)
s_barrier
ds_read_b128 v[80:83], v13 offset:0
ds_read_b128 v[84:87], v13 offset:1024
ds_read_b128 v[88:91], v13 offset:2048
ds_read_b128 v[92:95], v13 offset:3072
ds_read_b128 v[128:131], v13 offset:4096
ds_read_b128 v[132:135], v13 offset:5120
ds_read_b128 v[136:139], v13 offset:6144
ds_read_b128 v[140:143], v13 offset:7168
s_waitcnt lgkmcnt(7)
s_waitcnt lgkmcnt(15)
v_mfma_f32_32x32x16_bf16 v[16:31], v[104:107], v[80:83], v[16:31]
ds_read_b64_tr_b16 v[120:121], v168 offset:16384
ds_read_b64_tr_b16 v[122:123], v169 offset:24576
s_waitcnt lgkmcnt(15)
v_mfma_f32_32x32x16_bf16 v[32:47], v[108:111], v[80:83], v[32:47]
ds_read_b64_tr_b16 v[124:125], v170 offset:16384
ds_read_b64_tr_b16 v[126:127], v171 offset:24576
s_waitcnt lgkmcnt(15)
v_mfma_f32_32x32x16_bf16 v[48:63], v[112:115], v[80:83], v[48:63]
ds_read_b64_tr_b16 v[104:105], v172 offset:16384
ds_read_b64_tr_b16 v[106:107], v173 offset:24576
s_waitcnt lgkmcnt(15)
v_mfma_f32_32x32x16_bf16 v[64:79], v[116:119], v[80:83], v[64:79]
ds_read_b64_tr_b16 v[108:109], v174 offset:16384
ds_read_b64_tr_b16 v[110:111], v175 offset:24576
s_waitcnt lgkmcnt(14)
s_waitcnt lgkmcnt(6)
v_mfma_f32_32x32x16_bf16 v[16:31], v[120:123], v[84:87], v[16:31]
ds_read_b64_tr_b16 v[112:113], v168 offset:32768
ds_read_b64_tr_b16 v[114:115], v169 offset:40960
s_waitcnt lgkmcnt(6)
v_mfma_f32_32x32x16_bf16 v[32:47], v[124:127], v[84:87], v[32:47]
ds_read_b64_tr_b16 v[116:117], v170 offset:32768
ds_read_b64_tr_b16 v[118:119], v171 offset:40960
s_waitcnt lgkmcnt(6)
v_mfma_f32_32x32x16_bf16 v[48:63], v[104:107], v[84:87], v[48:63]
ds_read_b64_tr_b16 v[120:121], v172 offset:32768
ds_read_b64_tr_b16 v[122:123], v173 offset:40960
s_waitcnt lgkmcnt(6)
v_mfma_f32_32x32x16_bf16 v[64:79], v[108:111], v[84:87], v[64:79]
ds_read_b64_tr_b16 v[124:125], v174 offset:32768
ds_read_b64_tr_b16 v[126:127], v175 offset:40960
s_barrier
s_waitcnt lgkmcnt(15)
s_waitcnt lgkmcnt(6)
v_mfma_f32_32x32x16_bf16 v[16:31], v[112:115], v[88:91], v[16:31]
ds_read_b64_tr_b16 v[104:105], v168 offset:49152
ds_read_b64_tr_b16 v[106:107], v169 offset:57344
ds_write_b128 v4, a[0:3] offset:0
s_waitcnt lgkmcnt(7)
v_mfma_f32_32x32x16_bf16 v[32:47], v[116:119], v[88:91], v[32:47]
ds_read_b64_tr_b16 v[108:109], v170 offset:49152
ds_read_b64_tr_b16 v[110:111], v171 offset:57344
ds_write_b128 v4, a[4:7] offset:1024
s_waitcnt lgkmcnt(8)
v_mfma_f32_32x32x16_bf16 v[48:63], v[120:123], v[88:91], v[48:63]
ds_read_b64_tr_b16 v[112:113], v172 offset:49152
ds_read_b64_tr_b16 v[114:115], v173 offset:57344
ds_write_b128 v4, a[8:11] offset:2048
s_waitcnt lgkmcnt(9)
v_mfma_f32_32x32x16_bf16 v[64:79], v[124:127], v[88:91], v[64:79]
ds_read_b64_tr_b16 v[116:117], v174 offset:49152
ds_read_b64_tr_b16 v[118:119], v175 offset:57344
ds_write_b128 v4, a[12:15] offset:3072
s_waitcnt lgkmcnt(15)
s_waitcnt lgkmcnt(10)
v_mfma_f32_32x32x16_bf16 v[16:31], v[104:107], v[92:95], v[16:31]
v_add_u32 v168, 0x10000, v168
v_add_u32 v169, 0x10000, v169
v_add_u32 v170, 0x10000, v170
v_add_u32 v171, 0x10000, v171
v_add_u32 v172, 0x10000, v172
v_add_u32 v173, 0x10000, v173
v_add_u32 v174, 0x10000, v174
v_add_u32 v175, 0x10000, v175
ds_read_b64_tr_b16 v[120:121], v168 offset:0
ds_read_b64_tr_b16 v[122:123], v169 offset:8192
ds_write_b128 v4, a[16:19] offset:4096
s_waitcnt lgkmcnt(10)
v_mfma_f32_32x32x16_bf16 v[32:47], v[108:111], v[92:95], v[32:47]
ds_read_b64_tr_b16 v[124:125], v170 offset:0
ds_read_b64_tr_b16 v[126:127], v171 offset:8192
ds_write_b128 v4, a[20:23] offset:5120
s_waitcnt lgkmcnt(10)
v_mfma_f32_32x32x16_bf16 v[48:63], v[112:115], v[92:95], v[48:63]
ds_read_b64_tr_b16 v[104:105], v172 offset:0
ds_read_b64_tr_b16 v[106:107], v173 offset:8192
ds_write_b128 v4, a[24:27] offset:6144
s_waitcnt lgkmcnt(10)
v_mfma_f32_32x32x16_bf16 v[64:79], v[116:119], v[92:95], v[64:79]
ds_read_b64_tr_b16 v[108:109], v174 offset:0
ds_read_b64_tr_b16 v[110:111], v175 offset:8192
ds_write_b128 v4, a[28:31] offset:7168
s_barrier
s_waitcnt lgkmcnt(15)
s_waitcnt lgkmcnt(10)
v_mfma_f32_32x32x16_bf16 v[16:31], v[120:123], v[128:131], v[16:31]
ds_read_b64_tr_b16 v[112:113], v168 offset:16384
ds_read_b64_tr_b16 v[114:115], v169 offset:24576
ds_write_b128 v4, a[32:35] offset:32768
s_waitcnt lgkmcnt(10)
v_mfma_f32_32x32x16_bf16 v[32:47], v[124:127], v[128:131], v[32:47]
ds_read_b64_tr_b16 v[116:117], v170 offset:16384
ds_read_b64_tr_b16 v[118:119], v171 offset:24576
ds_write_b128 v4, a[36:39] offset:33792
s_waitcnt lgkmcnt(10)
v_mfma_f32_32x32x16_bf16 v[48:63], v[104:107], v[128:131], v[48:63]
ds_read_b64_tr_b16 v[120:121], v172 offset:16384
ds_read_b64_tr_b16 v[122:123], v173 offset:24576
ds_write_b128 v4, a[40:43] offset:34816
s_waitcnt lgkmcnt(10)
v_mfma_f32_32x32x16_bf16 v[64:79], v[108:111], v[128:131], v[64:79]
ds_read_b64_tr_b16 v[124:125], v174 offset:16384
ds_read_b64_tr_b16 v[126:127], v175 offset:24576
ds_write_b128 v4, a[44:47] offset:35840
s_waitcnt lgkmcnt(15)
s_waitcnt lgkmcnt(10)
v_mfma_f32_32x32x16_bf16 v[16:31], v[112:115], v[132:135], v[16:31]
ds_read_b64_tr_b16 v[104:105], v168 offset:32768
ds_read_b64_tr_b16 v[106:107], v169 offset:40960
ds_write_b128 v4, a[48:51] offset:36864
s_waitcnt lgkmcnt(10)
v_mfma_f32_32x32x16_bf16 v[32:47], v[116:119], v[132:135], v[32:47]
ds_read_b64_tr_b16 v[108:109], v170 offset:32768
ds_read_b64_tr_b16 v[110:111], v171 offset:40960
ds_write_b128 v4, a[52:55] offset:37888
s_waitcnt lgkmcnt(10)
v_mfma_f32_32x32x16_bf16 v[48:63], v[120:123], v[132:135], v[48:63]
ds_read_b64_tr_b16 v[112:113], v172 offset:32768
ds_read_b64_tr_b16 v[114:115], v173 offset:40960
ds_write_b128 v4, a[56:59] offset:38912
s_waitcnt lgkmcnt(10)
v_mfma_f32_32x32x16_bf16 v[64:79], v[124:127], v[132:135], v[64:79]
ds_read_b64_tr_b16 v[116:117], v174 offset:32768
ds_read_b64_tr_b16 v[118:119], v175 offset:40960
ds_write_b128 v4, a[60:63] offset:39936
s_barrier
s_waitcnt lgkmcnt(15)
s_waitcnt lgkmcnt(10)
v_mfma_f32_32x32x16_bf16 v[16:31], v[104:107], v[136:139], v[16:31]
ds_read_b64_tr_b16 v[120:121], v168 offset:49152
ds_read_b64_tr_b16 v[122:123], v169 offset:57344
s_waitcnt vmcnt(15)
ds_write_b128 v3, a[64:67] offset:0
s_waitcnt lgkmcnt(10)
v_mfma_f32_32x32x16_bf16 v[32:47], v[108:111], v[136:139], v[32:47]
ds_read_b64_tr_b16 v[124:125], v170 offset:49152
ds_read_b64_tr_b16 v[126:127], v171 offset:57344
s_waitcnt vmcnt(14)
ds_write_b128 v3, a[68:71] offset:1024
s_waitcnt lgkmcnt(10)
v_mfma_f32_32x32x16_bf16 v[48:63], v[112:115], v[136:139], v[48:63]
ds_read_b64_tr_b16 v[104:105], v172 offset:49152
ds_read_b64_tr_b16 v[106:107], v173 offset:57344
s_waitcnt vmcnt(13)
ds_write_b128 v3, a[72:75] offset:2048
s_waitcnt lgkmcnt(10)
v_mfma_f32_32x32x16_bf16 v[64:79], v[116:119], v[136:139], v[64:79]
ds_read_b64_tr_b16 v[108:109], v174 offset:49152
ds_read_b64_tr_b16 v[110:111], v175 offset:57344
s_waitcnt vmcnt(12)
ds_write_b128 v3, a[76:79] offset:3072
s_waitcnt lgkmcnt(15)
s_waitcnt lgkmcnt(10)
v_mfma_f32_32x32x16_bf16 v[16:31], v[120:123], v[140:143], v[16:31]
s_waitcnt vmcnt(11)
ds_write_b128 v3, a[80:83] offset:4096
s_waitcnt lgkmcnt(8)
v_mfma_f32_32x32x16_bf16 v[32:47], v[124:127], v[140:143], v[32:47]
s_waitcnt vmcnt(10)
ds_write_b128 v3, a[84:87] offset:5120
s_waitcnt lgkmcnt(6)
v_mfma_f32_32x32x16_bf16 v[48:63], v[104:107], v[140:143], v[48:63]
s_waitcnt vmcnt(9)
ds_write_b128 v3, a[88:91] offset:6144
s_waitcnt lgkmcnt(4)
v_mfma_f32_32x32x16_bf16 v[64:79], v[108:111], v[140:143], v[64:79]
s_waitcnt vmcnt(8)
ds_write_b128 v3, a[92:95] offset:7168
s_barrier
s_waitcnt vmcnt(7)
ds_write_b128 v3, a[96:99] offset:32768
s_waitcnt vmcnt(6)
ds_write_b128 v3, a[100:103] offset:33792
s_waitcnt vmcnt(5)
ds_write_b128 v3, a[104:107] offset:34816
s_waitcnt vmcnt(4)
ds_write_b128 v3, a[108:111] offset:35840
s_waitcnt vmcnt(3)
ds_write_b128 v3, a[112:115] offset:36864
s_waitcnt vmcnt(2)
ds_write_b128 v3, a[116:119] offset:37888
s_waitcnt vmcnt(1)
ds_write_b128 v3, a[120:123] offset:38912
s_waitcnt vmcnt(0)
ds_write_b128 v3, a[124:127] offset:39936
s_waitcnt lgkmcnt(0)
s_barrier
v_subrev_u32 v168, 0x10000, v168
v_subrev_u32 v169, 0x10000, v169
v_subrev_u32 v170, 0x10000, v170
v_subrev_u32 v171, 0x10000, v171
v_subrev_u32 v172, 0x10000, v172
v_subrev_u32 v173, 0x10000, v173
v_subrev_u32 v174, 0x10000, v174
v_subrev_u32 v175, 0x10000, v175
ds_read_b128 v[96:99], v184 offset:0
ds_read_b128 v[100:103], v185 offset:0
ds_read_b128 v[104:107], v186 offset:0
ds_read_b128 v[108:111], v187 offset:0
ds_read_b128 v[112:115], v188 offset:0
ds_read_b128 v[116:119], v189 offset:0
ds_read_b128 v[120:123], v190 offset:0
ds_read_b128 v[124:127], v191 offset:0
s_waitcnt lgkmcnt(7)
v_mfma_f32_32x32x16_bf16 v[80:95], v[96:99], a[128:131], 0
ds_read_b128 v[96:99], v184 offset:256
s_waitcnt lgkmcnt(7)
v_mfma_f32_32x32x16_bf16 v[80:95], v[100:103], a[132:135], v[80:95]
ds_read_b128 v[100:103], v185 offset:256
s_waitcnt lgkmcnt(7)
v_mfma_f32_32x32x16_bf16 v[80:95], v[104:107], a[136:139], v[80:95]
ds_read_b128 v[104:107], v186 offset:256
s_waitcnt lgkmcnt(7)
v_mfma_f32_32x32x16_bf16 v[80:95], v[108:111], a[140:143], v[80:95]
ds_read_b128 v[108:111], v187 offset:256
s_waitcnt lgkmcnt(7)
v_mfma_f32_32x32x16_bf16 v[80:95], v[112:115], a[144:147], v[80:95]
ds_read_b128 v[112:115], v188 offset:256
s_waitcnt lgkmcnt(7)
v_mfma_f32_32x32x16_bf16 v[80:95], v[116:119], a[148:151], v[80:95]
ds_read_b128 v[116:119], v189 offset:256
s_waitcnt lgkmcnt(7)
v_mfma_f32_32x32x16_bf16 v[80:95], v[120:123], a[152:155], v[80:95]
ds_read_b128 v[120:123], v190 offset:256
s_waitcnt lgkmcnt(7)
v_mfma_f32_32x32x16_bf16 v[80:95], v[124:127], a[156:159], v[80:95]
ds_read_b128 v[124:127], v191 offset:256
s_waitcnt lgkmcnt(7)
v_mfma_f32_32x32x16_bf16 v[80:95], v[96:99], a[160:163], v[80:95]
ds_read_b128 v[96:99], v184 offset:512
s_waitcnt lgkmcnt(7)
v_mfma_f32_32x32x16_bf16 v[80:95], v[100:103], a[164:167], v[80:95]
ds_read_b128 v[100:103], v185 offset:512
s_waitcnt lgkmcnt(7)
v_mfma_f32_32x32x16_bf16 v[80:95], v[104:107], a[168:171], v[80:95]
ds_read_b128 v[104:107], v186 offset:512
s_waitcnt lgkmcnt(7)
v_mfma_f32_32x32x16_bf16 v[80:95], v[108:111], a[172:175], v[80:95]
ds_read_b128 v[108:111], v187 offset:512
s_waitcnt lgkmcnt(7)
v_mfma_f32_32x32x16_bf16 v[80:95], v[112:115], a[176:179], v[80:95]
ds_read_b128 v[112:115], v188 offset:512
s_waitcnt lgkmcnt(7)
v_mfma_f32_32x32x16_bf16 v[80:95], v[116:119], a[180:183], v[80:95]
ds_read_b128 v[116:119], v189 offset:512
s_waitcnt lgkmcnt(7)
v_mfma_f32_32x32x16_bf16 v[80:95], v[120:123], a[184:187], v[80:95]
ds_read_b128 v[120:123], v190 offset:512
s_waitcnt lgkmcnt(7)
v_mfma_f32_32x32x16_bf16 v[80:95], v[124:127], a[188:191], v[80:95]
ds_read_b128 v[124:127], v191 offset:512
s_waitcnt lgkmcnt(7)
v_mfma_f32_32x32x16_bf16 v[80:95], v[96:99], a[192:195], v[80:95]
ds_read_b128 v[96:99], v184 offset:768
s_waitcnt lgkmcnt(7)
v_mfma_f32_32x32x16_bf16 v[80:95], v[100:103], a[196:199], v[80:95]
ds_read_b128 v[100:103], v185 offset:768
s_waitcnt lgkmcnt(7)
v_mfma_f32_32x32x16_bf16 v[80:95], v[104:107], a[200:203], v[80:95]
ds_read_b128 v[104:107], v186 offset:768
s_waitcnt lgkmcnt(7)
v_mfma_f32_32x32x16_bf16 v[80:95], v[108:111], a[204:207], v[80:95]
ds_read_b128 v[108:111], v187 offset:768
s_waitcnt lgkmcnt(7)
v_mfma_f32_32x32x16_bf16 v[80:95], v[112:115], a[208:211], v[80:95]
ds_read_b128 v[112:115], v188 offset:768
s_waitcnt lgkmcnt(7)
v_mfma_f32_32x32x16_bf16 v[80:95], v[116:119], a[212:215], v[80:95]
ds_read_b128 v[116:119], v189 offset:768
s_waitcnt lgkmcnt(7)
v_mfma_f32_32x32x16_bf16 v[80:95], v[120:123], a[216:219], v[80:95]
ds_read_b128 v[120:123], v190 offset:768
s_waitcnt lgkmcnt(7)
v_mfma_f32_32x32x16_bf16 v[80:95], v[124:127], a[220:223], v[80:95]
ds_read_b128 v[124:127], v191 offset:768
s_waitcnt lgkmcnt(7)
v_mfma_f32_32x32x16_bf16 v[80:95], v[96:99], a[224:227], v[80:95]
s_waitcnt lgkmcnt(6)
v_mfma_f32_32x32x16_bf16 v[80:95], v[100:103], a[228:231], v[80:95]
s_waitcnt lgkmcnt(5)
v_mfma_f32_32x32x16_bf16 v[80:95], v[104:107], a[232:235], v[80:95]
s_waitcnt lgkmcnt(4)
v_mfma_f32_32x32x16_bf16 v[80:95], v[108:111], a[236:239], v[80:95]
s_waitcnt lgkmcnt(3)
v_mfma_f32_32x32x16_bf16 v[80:95], v[112:115], a[240:243], v[80:95]
s_waitcnt lgkmcnt(2)
v_mfma_f32_32x32x16_bf16 v[80:95], v[116:119], a[244:247], v[80:95]
s_waitcnt lgkmcnt(1)
v_mfma_f32_32x32x16_bf16 v[80:95], v[120:123], a[248:251], v[80:95]
s_waitcnt lgkmcnt(0)
v_mfma_f32_32x32x16_bf16 v[80:95], v[124:127], a[252:255], v[80:95]
s_nop 11
s_nop 3
v_max3_f32 v96, v80, v81, v82
v_max3_f32 v97, v83, v84, v85
v_max3_f32 v98, v86, v87, v88
v_max3_f32 v99, v89, v90, v91
v_max3_f32 v96, v96, v92, v93
v_max3_f32 v97, v97, v94, v95
v_max3_f32 v96, v96, v97, v98
v_max_f32 v96, v96, v99
v_mov_b32 v97, v96
s_nop 1
v_permlane32_swap_b32 v97, v96
s_nop 1
v_max_f32 v96, v96, v97
ds_write_b32 v11, v96
s_waitcnt lgkmcnt(0)
s_barrier
ds_read_b32 v96, v10
ds_read_b32 v97, v10 offset:128
ds_read_b32 v98, v10 offset:256
ds_read_b32 v99, v10 offset:384
ds_read_b64_tr_b16 v[104:105], v168 offset:0
ds_read_b64_tr_b16 v[106:107], v169 offset:8192
ds_read_b64_tr_b16 v[108:109], v170 offset:0
ds_read_b64_tr_b16 v[110:111], v171 offset:8192
ds_read_b64_tr_b16 v[112:113], v172 offset:0
ds_read_b64_tr_b16 v[114:115], v173 offset:8192
ds_read_b64_tr_b16 v[116:117], v174 offset:0
ds_read_b64_tr_b16 v[118:119], v175 offset:8192
s_waitcnt lgkmcnt(8)
v_max3_f32 v96, v96, v97, v98
v_max3_f32 v96, v96, v99, v8
v_sub_f32 v2, v8, v96
v_exp_f32 v2, v2
v_mov_b32 v8, v96
v_sub_f32 v100, 0, v96
v_sub_f32 v101, 0, v96
v_pk_add_f32 v[80:81], v[80:81], v[100:101]
v_pk_add_f32 v[82:83], v[82:83], v[100:101]
v_pk_add_f32 v[84:85], v[84:85], v[100:101]
v_pk_add_f32 v[86:87], v[86:87], v[100:101]
v_pk_add_f32 v[88:89], v[88:89], v[100:101]
v_pk_add_f32 v[90:91], v[90:91], v[100:101]
v_pk_add_f32 v[92:93], v[92:93], v[100:101]
v_pk_add_f32 v[94:95], v[94:95], v[100:101]
v_exp_f32 v80, v80
v_exp_f32 v81, v81
v_exp_f32 v82, v82
v_exp_f32 v83, v83
v_exp_f32 v84, v84
v_exp_f32 v85, v85
v_exp_f32 v86, v86
v_exp_f32 v87, v87
v_exp_f32 v88, v88
v_exp_f32 v89, v89
v_exp_f32 v90, v90
v_exp_f32 v91, v91
v_exp_f32 v92, v92
v_exp_f32 v93, v93
v_exp_f32 v94, v94
v_exp_f32 v95, v95
v_mov_b32 v3, v2
s_nop 0
v_cvt_pk_bf16_f32 v96, v80, v81
v_cvt_pk_bf16_f32 v97, v82, v83
v_cvt_pk_bf16_f32 v98, v84, v85
v_cvt_pk_bf16_f32 v99, v86, v87
v_cvt_pk_bf16_f32 v100, v88, v89
v_cvt_pk_bf16_f32 v101, v90, v91
v_cvt_pk_bf16_f32 v102, v92, v93
v_cvt_pk_bf16_f32 v103, v94, v95
ds_write_b128 v12, v[96:99]
ds_write_b128 v12, v[100:103] offset:1024
v_pk_mul_f32 v[14:15], v[14:15], v[2:3]
v_pk_add_f32 v[14:15], v[14:15], v[80:81]
v_pk_add_f32 v[14:15], v[14:15], v[82:83]
v_pk_add_f32 v[14:15], v[14:15], v[84:85]
v_pk_add_f32 v[14:15], v[14:15], v[86:87]
v_pk_add_f32 v[14:15], v[14:15], v[88:89]
v_pk_add_f32 v[14:15], v[14:15], v[90:91]
v_pk_add_f32 v[14:15], v[14:15], v[92:93]
v_pk_add_f32 v[14:15], v[14:15], v[94:95]
v_pk_mul_f32 v[16:17], v[16:17], v[2:3]
v_pk_mul_f32 v[18:19], v[18:19], v[2:3]
v_pk_mul_f32 v[20:21], v[20:21], v[2:3]
v_pk_mul_f32 v[22:23], v[22:23], v[2:3]
v_pk_mul_f32 v[24:25], v[24:25], v[2:3]
v_pk_mul_f32 v[26:27], v[26:27], v[2:3]
v_pk_mul_f32 v[28:29], v[28:29], v[2:3]
v_pk_mul_f32 v[30:31], v[30:31], v[2:3]
v_pk_mul_f32 v[32:33], v[32:33], v[2:3]
v_pk_mul_f32 v[34:35], v[34:35], v[2:3]
v_pk_mul_f32 v[36:37], v[36:37], v[2:3]
v_pk_mul_f32 v[38:39], v[38:39], v[2:3]
v_pk_mul_f32 v[40:41], v[40:41], v[2:3]
v_pk_mul_f32 v[42:43], v[42:43], v[2:3]
v_pk_mul_f32 v[44:45], v[44:45], v[2:3]
v_pk_mul_f32 v[46:47], v[46:47], v[2:3]
v_pk_mul_f32 v[48:49], v[48:49], v[2:3]
v_pk_mul_f32 v[50:51], v[50:51], v[2:3]
v_pk_mul_f32 v[52:53], v[52:53], v[2:3]
v_pk_mul_f32 v[54:55], v[54:55], v[2:3]
v_pk_mul_f32 v[56:57], v[56:57], v[2:3]
v_pk_mul_f32 v[58:59], v[58:59], v[2:3]
v_pk_mul_f32 v[60:61], v[60:61], v[2:3]
v_pk_mul_f32 v[62:63], v[62:63], v[2:3]
v_pk_mul_f32 v[64:65], v[64:65], v[2:3]
v_pk_mul_f32 v[66:67], v[66:67], v[2:3]
v_pk_mul_f32 v[68:69], v[68:69], v[2:3]
v_pk_mul_f32 v[70:71], v[70:71], v[2:3]
v_pk_mul_f32 v[72:73], v[72:73], v[2:3]
v_pk_mul_f32 v[74:75], v[74:75], v[2:3]
v_pk_mul_f32 v[76:77], v[76:77], v[2:3]
v_pk_mul_f32 v[78:79], v[78:79], v[2:3]
s_waitcnt lgkmcnt(0)
s_barrier
ds_read_b128 v[80:83], v13 offset:0
ds_read_b128 v[84:87], v13 offset:1024
ds_read_b128 v[88:91], v13 offset:2048
ds_read_b128 v[92:95], v13 offset:3072
ds_read_b128 v[128:131], v13 offset:4096
ds_read_b128 v[132:135], v13 offset:5120
ds_read_b128 v[136:139], v13 offset:6144
ds_read_b128 v[140:143], v13 offset:7168
s_waitcnt lgkmcnt(7)
s_waitcnt lgkmcnt(15)
v_mfma_f32_32x32x16_bf16 v[16:31], v[104:107], v[80:83], v[16:31]
ds_read_b64_tr_b16 v[120:121], v168 offset:16384
ds_read_b64_tr_b16 v[122:123], v169 offset:24576
s_waitcnt lgkmcnt(15)
v_mfma_f32_32x32x16_bf16 v[32:47], v[108:111], v[80:83], v[32:47]
ds_read_b64_tr_b16 v[124:125], v170 offset:16384
ds_read_b64_tr_b16 v[126:127], v171 offset:24576
s_waitcnt lgkmcnt(15)
v_mfma_f32_32x32x16_bf16 v[48:63], v[112:115], v[80:83], v[48:63]
ds_read_b64_tr_b16 v[104:105], v172 offset:16384
ds_read_b64_tr_b16 v[106:107], v173 offset:24576
s_waitcnt lgkmcnt(15)
v_mfma_f32_32x32x16_bf16 v[64:79], v[116:119], v[80:83], v[64:79]
ds_read_b64_tr_b16 v[108:109], v174 offset:16384
ds_read_b64_tr_b16 v[110:111], v175 offset:24576
s_waitcnt lgkmcnt(14)
s_waitcnt lgkmcnt(6)
v_mfma_f32_32x32x16_bf16 v[16:31], v[120:123], v[84:87], v[16:31]
ds_read_b64_tr_b16 v[112:113], v168 offset:32768
ds_read_b64_tr_b16 v[114:115], v169 offset:40960
s_waitcnt lgkmcnt(6)
v_mfma_f32_32x32x16_bf16 v[32:47], v[124:127], v[84:87], v[32:47]
ds_read_b64_tr_b16 v[116:117], v170 offset:32768
ds_read_b64_tr_b16 v[118:119], v171 offset:40960
s_waitcnt lgkmcnt(6)
v_mfma_f32_32x32x16_bf16 v[48:63], v[104:107], v[84:87], v[48:63]
ds_read_b64_tr_b16 v[120:121], v172 offset:32768
ds_read_b64_tr_b16 v[122:123], v173 offset:40960
s_waitcnt lgkmcnt(6)
v_mfma_f32_32x32x16_bf16 v[64:79], v[108:111], v[84:87], v[64:79]
ds_read_b64_tr_b16 v[124:125], v174 offset:32768
ds_read_b64_tr_b16 v[126:127], v175 offset:40960
s_waitcnt lgkmcnt(15)
s_waitcnt lgkmcnt(6)
v_mfma_f32_32x32x16_bf16 v[16:31], v[112:115], v[88:91], v[16:31]
ds_read_b64_tr_b16 v[104:105], v168 offset:49152
ds_read_b64_tr_b16 v[106:107], v169 offset:57344
s_waitcnt lgkmcnt(6)
v_mfma_f32_32x32x16_bf16 v[32:47], v[116:119], v[88:91], v[32:47]
ds_read_b64_tr_b16 v[108:109], v170 offset:49152
ds_read_b64_tr_b16 v[110:111], v171 offset:57344
s_waitcnt lgkmcnt(6)
v_mfma_f32_32x32x16_bf16 v[48:63], v[120:123], v[88:91], v[48:63]
ds_read_b64_tr_b16 v[112:113], v172 offset:49152
ds_read_b64_tr_b16 v[114:115], v173 offset:57344
s_waitcnt lgkmcnt(6)
v_mfma_f32_32x32x16_bf16 v[64:79], v[124:127], v[88:91], v[64:79]
ds_read_b64_tr_b16 v[116:117], v174 offset:49152
ds_read_b64_tr_b16 v[118:119], v175 offset:57344
s_waitcnt lgkmcnt(15)
s_waitcnt lgkmcnt(6)
v_mfma_f32_32x32x16_bf16 v[16:31], v[104:107], v[92:95], v[16:31]
v_add_u32 v168, 0x10000, v168
v_add_u32 v169, 0x10000, v169
v_add_u32 v170, 0x10000, v170
v_add_u32 v171, 0x10000, v171
v_add_u32 v172, 0x10000, v172
v_add_u32 v173, 0x10000, v173
v_add_u32 v174, 0x10000, v174
v_add_u32 v175, 0x10000, v175
ds_read_b64_tr_b16 v[120:121], v168 offset:0
ds_read_b64_tr_b16 v[122:123], v169 offset:8192
s_waitcnt lgkmcnt(6)
v_mfma_f32_32x32x16_bf16 v[32:47], v[108:111], v[92:95], v[32:47]
ds_read_b64_tr_b16 v[124:125], v170 offset:0
ds_read_b64_tr_b16 v[126:127], v171 offset:8192
s_waitcnt lgkmcnt(6)
v_mfma_f32_32x32x16_bf16 v[48:63], v[112:115], v[92:95], v[48:63]
ds_read_b64_tr_b16 v[104:105], v172 offset:0
ds_read_b64_tr_b16 v[106:107], v173 offset:8192
s_waitcnt lgkmcnt(6)
v_mfma_f32_32x32x16_bf16 v[64:79], v[116:119], v[92:95], v[64:79]
ds_read_b64_tr_b16 v[108:109], v174 offset:0
ds_read_b64_tr_b16 v[110:111], v175 offset:8192
s_waitcnt lgkmcnt(15)
s_waitcnt lgkmcnt(6)
v_mfma_f32_32x32x16_bf16 v[16:31], v[120:123], v[128:131], v[16:31]
ds_read_b64_tr_b16 v[112:113], v168 offset:16384
ds_read_b64_tr_b16 v[114:115], v169 offset:24576
s_waitcnt lgkmcnt(6)
v_mfma_f32_32x32x16_bf16 v[32:47], v[124:127], v[128:131], v[32:47]
ds_read_b64_tr_b16 v[116:117], v170 offset:16384
ds_read_b64_tr_b16 v[118:119], v171 offset:24576
s_waitcnt lgkmcnt(6)
v_mfma_f32_32x32x16_bf16 v[48:63], v[104:107], v[128:131], v[48:63]
ds_read_b64_tr_b16 v[120:121], v172 offset:16384
ds_read_b64_tr_b16 v[122:123], v173 offset:24576
s_waitcnt lgkmcnt(6)
v_mfma_f32_32x32x16_bf16 v[64:79], v[108:111], v[128:131], v[64:79]
ds_read_b64_tr_b16 v[124:125], v174 offset:16384
ds_read_b64_tr_b16 v[126:127], v175 offset:24576
s_waitcnt lgkmcnt(15)
s_waitcnt lgkmcnt(6)
v_mfma_f32_32x32x16_bf16 v[16:31], v[112:115], v[132:135], v[16:31]
ds_read_b64_tr_b16 v[104:105], v168 offset:32768
ds_read_b64_tr_b16 v[106:107], v169 offset:40960
s_waitcnt lgkmcnt(6)
v_mfma_f32_32x32x16_bf16 v[32:47], v[116:119], v[132:135], v[32:47]
ds_read_b64_tr_b16 v[108:109], v170 offset:32768
ds_read_b64_tr_b16 v[110:111], v171 offset:40960
s_waitcnt lgkmcnt(6)
v_mfma_f32_32x32x16_bf16 v[48:63], v[120:123], v[132:135], v[48:63]
ds_read_b64_tr_b16 v[112:113], v172 offset:32768
ds_read_b64_tr_b16 v[114:115], v173 offset:40960
s_waitcnt lgkmcnt(6)
v_mfma_f32_32x32x16_bf16 v[64:79], v[124:127], v[132:135], v[64:79]
ds_read_b64_tr_b16 v[116:117], v174 offset:32768
ds_read_b64_tr_b16 v[118:119], v175 offset:40960
s_waitcnt lgkmcnt(15)
s_waitcnt lgkmcnt(6)
v_mfma_f32_32x32x16_bf16 v[16:31], v[104:107], v[136:139], v[16:31]
ds_read_b64_tr_b16 v[120:121], v168 offset:49152
ds_read_b64_tr_b16 v[122:123], v169 offset:57344
s_waitcnt lgkmcnt(6)
v_mfma_f32_32x32x16_bf16 v[32:47], v[108:111], v[136:139], v[32:47]
ds_read_b64_tr_b16 v[124:125], v170 offset:49152
ds_read_b64_tr_b16 v[126:127], v171 offset:57344
s_waitcnt lgkmcnt(6)
v_mfma_f32_32x32x16_bf16 v[48:63], v[112:115], v[136:139], v[48:63]
ds_read_b64_tr_b16 v[104:105], v172 offset:49152
ds_read_b64_tr_b16 v[106:107], v173 offset:57344
s_waitcnt lgkmcnt(6)
v_mfma_f32_32x32x16_bf16 v[64:79], v[116:119], v[136:139], v[64:79]
ds_read_b64_tr_b16 v[108:109], v174 offset:49152
ds_read_b64_tr_b16 v[110:111], v175 offset:57344
s_waitcnt lgkmcnt(15)
s_waitcnt lgkmcnt(6)
v_mfma_f32_32x32x16_bf16 v[16:31], v[120:123], v[140:143], v[16:31]
s_waitcnt lgkmcnt(4)
v_mfma_f32_32x32x16_bf16 v[32:47], v[124:127], v[140:143], v[32:47]
s_waitcnt lgkmcnt(2)
v_mfma_f32_32x32x16_bf16 v[48:63], v[104:107], v[140:143], v[48:63]
s_waitcnt lgkmcnt(0)
v_mfma_f32_32x32x16_bf16 v[64:79], v[108:111], v[140:143], v[64:79]
v_subrev_u32 v168, 0x10000, v168
v_subrev_u32 v169, 0x10000, v169
v_subrev_u32 v170, 0x10000, v170
v_subrev_u32 v171, 0x10000, v171
v_subrev_u32 v172, 0x10000, v172
v_subrev_u32 v173, 0x10000, v173
v_subrev_u32 v174, 0x10000, v174
v_subrev_u32 v175, 0x10000, v175
v_add_f32 v9, v14, v15
s_nop 11
s_nop 3
v_mov_b32 v15, v9
s_nop 1
v_permlane32_swap_b32 v15, v9
s_nop 1
v_add_f32 v9, v9, v15
s_barrier
ds_write_b32 v11, v9
s_mul_i32 s27, s21, 8704
v_mul_u32_u24 v14, 272, v6
v_lshl_add_u32 v14, v7, 3, v14
v_add_u32 v14, s27, v14
v_cvt_pk_bf16_f32 v100, v16, v17
v_cvt_pk_bf16_f32 v101, v18, v19
ds_write_b64 v14, v[100:101] offset:0
v_cvt_pk_bf16_f32 v102, v20, v21
v_cvt_pk_bf16_f32 v103, v22, v23
ds_write_b64 v14, v[102:103] offset:16
v_cvt_pk_bf16_f32 v104, v24, v25
v_cvt_pk_bf16_f32 v105, v26, v27
ds_write_b64 v14, v[104:105] offset:32
v_cvt_pk_bf16_f32 v106, v28, v29
v_cvt_pk_bf16_f32 v107, v30, v31
ds_write_b64 v14, v[106:107] offset:48
v_cvt_pk_bf16_f32 v108, v32, v33
v_cvt_pk_bf16_f32 v109, v34, v35
ds_write_b64 v14, v[108:109] offset:64
v_cvt_pk_bf16_f32 v110, v36, v37
v_cvt_pk_bf16_f32 v111, v38, v39
ds_write_b64 v14, v[110:111] offset:80
v_cvt_pk_bf16_f32 v112, v40, v41
v_cvt_pk_bf16_f32 v113, v42, v43
ds_write_b64 v14, v[112:113] offset:96
v_cvt_pk_bf16_f32 v114, v44, v45
v_cvt_pk_bf16_f32 v115, v46, v47
ds_write_b64 v14, v[114:115] offset:112
v_cvt_pk_bf16_f32 v100, v48, v49
v_cvt_pk_bf16_f32 v101, v50, v51
ds_write_b64 v14, v[100:101] offset:128
v_cvt_pk_bf16_f32 v102, v52, v53
v_cvt_pk_bf16_f32 v103, v54, v55
ds_write_b64 v14, v[102:103] offset:144
v_cvt_pk_bf16_f32 v104, v56, v57
v_cvt_pk_bf16_f32 v105, v58, v59
ds_write_b64 v14, v[104:105] offset:160
v_cvt_pk_bf16_f32 v106, v60, v61
v_cvt_pk_bf16_f32 v107, v62, v63
ds_write_b64 v14, v[106:107] offset:176
v_cvt_pk_bf16_f32 v108, v64, v65
v_cvt_pk_bf16_f32 v109, v66, v67
ds_write_b64 v14, v[108:109] offset:192
v_cvt_pk_bf16_f32 v110, v68, v69
v_cvt_pk_bf16_f32 v111, v70, v71
ds_write_b64 v14, v[110:111] offset:208
v_cvt_pk_bf16_f32 v112, v72, v73
v_cvt_pk_bf16_f32 v113, v74, v75
ds_write_b64 v14, v[112:113] offset:224
v_cvt_pk_bf16_f32 v114, v76, v77
v_cvt_pk_bf16_f32 v115, v78, v79
ds_write_b64 v14, v[114:115] offset:240
v_lshrrev_b32 v15, 4, v1
v_and_b32 v96, 15, v1
v_mul_u32_u24 v14, 272, v15
v_lshl_add_u32 v14, v96, 4, v14
v_add_u32 v14, s27, v14
v_lshlrev_b32 v2, 2, v15
v_lshlrev_b32 v15, 17, v15
v_lshl_add_u32 v15, v96, 4, v15
s_lshl_b32 s27, s21, 15
s_add_u32 s27, s27, 4194304
s_add_u32 s33, s22, s21
v_add_u32 v2, s33, v2
s_waitcnt lgkmcnt(0)
ds_read_b128 v[96:99], v14 offset:0
ds_read_b128 v[100:103], v14 offset:1088
ds_read_b128 v[104:107], v14 offset:2176
ds_read_b128 v[108:111], v14 offset:3264
ds_read_b128 v[112:115], v14 offset:4352
ds_read_b128 v[116:119], v14 offset:5440
ds_read_b128 v[120:123], v14 offset:6528
ds_read_b128 v[124:127], v14 offset:7616
s_waitcnt lgkmcnt(7)
v_add_u32 v3, 0, v2
v_and_b32 v3, 127, v3
v_lshl_add_u32 v3, v3, 8, v15
s_add_u32 s30, s27, 0
buffer_store_dwordx4 v[96:99], v3, s[4:7], s30 offen sc0 sc1
s_waitcnt lgkmcnt(6)
v_add_u32 v3, 16, v2
v_and_b32 v3, 127, v3
v_lshl_add_u32 v3, v3, 8, v15
s_add_u32 s30, s27, 524288
buffer_store_dwordx4 v[100:103], v3, s[4:7], s30 offen sc0 sc1
s_waitcnt lgkmcnt(5)
v_add_u32 v3, 32, v2
v_and_b32 v3, 127, v3
v_lshl_add_u32 v3, v3, 8, v15
s_add_u32 s30, s27, 1048576
buffer_store_dwordx4 v[104:107], v3, s[4:7], s30 offen sc0 sc1
s_waitcnt lgkmcnt(4)
v_add_u32 v3, 48, v2
v_and_b32 v3, 127, v3
v_lshl_add_u32 v3, v3, 8, v15
s_add_u32 s30, s27, 1572864
buffer_store_dwordx4 v[108:111], v3, s[4:7], s30 offen sc0 sc1
s_waitcnt lgkmcnt(3)
v_add_u32 v3, 64, v2
v_and_b32 v3, 127, v3
v_lshl_add_u32 v3, v3, 8, v15
s_add_u32 s30, s27, 2097152
buffer_store_dwordx4 v[112:115], v3, s[4:7], s30 offen sc0 sc1
s_waitcnt lgkmcnt(2)
v_add_u32 v3, 80, v2
v_and_b32 v3, 127, v3
v_lshl_add_u32 v3, v3, 8, v15
s_add_u32 s30, s27, 2621440
buffer_store_dwordx4 v[116:119], v3, s[4:7], s30 offen sc0 sc1
s_waitcnt lgkmcnt(1)
v_add_u32 v3, 96, v2
v_and_b32 v3, 127, v3
v_lshl_add_u32 v3, v3, 8, v15
s_add_u32 s30, s27, 3145728
buffer_store_dwordx4 v[120:123], v3, s[4:7], s30 offen sc0 sc1
s_waitcnt lgkmcnt(0)
v_add_u32 v3, 112, v2
v_and_b32 v3, 127, v3
v_lshl_add_u32 v3, v3, 8, v15
s_add_u32 s30, s27, 3670016
buffer_store_dwordx4 v[124:127], v3, s[4:7], s30 offen sc0 sc1
s_waitcnt vmcnt(0)
s_barrier
s_cmp_lg_u32 s21, 0
s_cbranch_scc1 L_a_nost
v_cmp_gt_u32 vcc, 32, v0
s_and_saveexec_b64 s[28:29], vcc
s_cbranch_execz skip_4
ds_read_b32 v96, v10
ds_read_b32 v97, v10 offset:128
ds_read_b32 v98, v10 offset:256
ds_read_b32 v99, v10 offset:384
s_waitcnt lgkmcnt(0)
v_add_f32 v96, v96, v97
v_add_f32 v98, v98, v99
v_add_f32 v98, v98, v96
v_mov_b32 v96, v8
v_mov_b32 v97, s20
v_mov_b32 v99, s20
v_lshlrev_b32 v14, 11, v0
s_lshl_b32 s27, s22, 4
s_add_u32 s27, s27, 524288
buffer_store_dwordx4 v[96:99], v14, s[4:7], s27 offen sc1
skip_4:
s_mov_b64 exec, s[28:29]
L_a_nost:
v_lshrrev_b32 v3, 4, v0
v_and_b32 v4, 15, v0
v_lshrrev_b32 v5, 2, v0
v_and_b32 v6, 3, v0
s_cmp_ge_u32 s22, 54
s_cbranch_scc1 L_notP7
s_mov_b32 s12, s50
s_mov_b32 s13, s51
s_mov_b32 s14, 0x21c000
s_mov_b32 s15, 0x20000
s_mov_b32 s8, s52
s_mov_b32 s9, s53
s_mov_b32 s10, 0x21c000
s_mov_b32 s11, 0x20000
s_mov_b32 s27, 34560
v_mul_lo_u32 v12, v5, s27
v_lshl_add_u32 v12, v6, 4, v12
s_lshl_b32 s27, s22, 6
s_add_u32 s30, s27, 0
buffer_load_dwordx4 v[96:99], v12, s[12:15], s30 offen nt
s_add_u32 s30, s27, 3456
buffer_load_dwordx4 v[100:103], v12, s[12:15], s30 offen nt
s_add_u32 s30, s27, 6912
buffer_load_dwordx4 v[104:107], v12, s[12:15], s30 offen nt
s_add_u32 s30, s27, 10368
buffer_load_dwordx4 v[108:111], v12, s[12:15], s30 offen nt
s_add_u32 s30, s27, 13824
buffer_load_dwordx4 v[112:115], v12, s[12:15], s30 offen nt
s_add_u32 s30, s27, 17280
buffer_load_dwordx4 v[116:119], v12, s[12:15], s30 offen nt
s_add_u32 s30, s27, 20736
buffer_load_dwordx4 v[120:123], v12, s[12:15], s30 offen nt
s_add_u32 s30, s27, 24192
buffer_load_dwordx4 v[124:127], v12, s[12:15], s30 offen nt
s_add_u32 s30, s27, 27648
buffer_load_dwordx4 v[128:131], v12, s[12:15], s30 offen nt
s_add_u32 s30, s27, 31104
buffer_load_dwordx4 v[132:135], v12, s[12:15], s30 offen nt
v_mul_u32_u24 v13, 205, v0
v_lshrrev_b32 v13, 14, v13
v_mul_u32_u24 v14, 80, v13
v_sub_u32 v14, v0, v14
v_mul_u32_u24 v15, 15360, v13
v_lshl_add_u32 v15, v14, 4, v15
s_mov_b32 s16, s36
s_mov_b32 s17, s37
s_mov_b32 s18, 0x500
s_mov_b32 s19, 0x20000
v_min_u32 v7, 159, v0
v_lshlrev_b32 v8, 3, v7
buffer_load_dwordx2 v[16:17], v8, s[16:19], 0 offen
v_cmp_gt_u32 vcc, 24, v0
s_and_saveexec_b64 s[28:29], vcc
s_cbranch_execz skip_5
v_lshlrev_b32 v9, 2, v0
v_mov_b32 v10, 0
ds_write_b32 v9, v10 offset:12288
skip_5:
s_mov_b64 exec, s[28:29]
v_lshlrev_b32 v8, 5, v7
s_mov_b32 s84, 393216
s_mov_b32 s85, 398336
s_mov_b32 s86, 403456
s_mov_b32 s26, 100000
g_6:
buffer_load_dwordx4 v[208:211], v8, s[4:7], s84 offen offset:0 sc1
buffer_load_dwordx4 v[212:215], v8, s[4:7], s84 offen offset:16 sc1
buffer_load_dwordx4 v[216:219], v8, s[4:7], s85 offen offset:0 sc1
buffer_load_dwordx4 v[220:223], v8, s[4:7], s85 offen offset:16 sc1
buffer_load_dwordx4 v[224:227], v8, s[4:7], s86 offen offset:0 sc1
buffer_load_dwordx4 v[228:231], v8, s[4:7], s86 offen offset:16 sc1
s_waitcnt vmcnt(0)
v_xor_b32 v60, s20, v209
v_xor_b32 v61, s20, v211
v_or_b32 v60, v60, v61
v_xor_b32 v61, s20, v213
v_or_b32 v60, v60, v61
v_xor_b32 v61, s20, v215
v_or_b32 v60, v60, v61
v_xor_b32 v61, s20, v217
v_or_b32 v60, v60, v61
v_xor_b32 v61, s20, v219
v_or_b32 v60, v60, v61
v_xor_b32 v61, s20, v221
v_or_b32 v60, v60, v61
v_xor_b32 v61, s20, v223
v_or_b32 v60, v60, v61
v_xor_b32 v61, s20, v225
v_or_b32 v60, v60, v61
v_xor_b32 v61, s20, v227
v_or_b32 v60, v60, v61
v_xor_b32 v61, s20, v229
v_or_b32 v60, v60, v61
v_xor_b32 v61, s20, v231
v_or_b32 v60, v60, v61
v_cmp_ne_u32 vcc, 0, v60
s_cbranch_vccz gd_7
s_sub_u32 s26, s26, 1
s_cmp_eq_u32 s26, 0
s_cbranch_scc1 gd_7
s_sleep 1
s_branch g_6
gd_7:
v_perm_b32 v62, v100, v96, s24
v_perm_b32 v100, v100, v96, s25
v_mov_b32 v96, v62
v_perm_b32 v62, v101, v97, s24
v_perm_b32 v101, v101, v97, s25
v_mov_b32 v97, v62
v_perm_b32 v62, v102, v98, s24
v_perm_b32 v102, v102, v98, s25
v_mov_b32 v98, v62
v_perm_b32 v62, v103, v99, s24
v_perm_b32 v103, v103, v99, s25
v_mov_b32 v99, v62
v_perm_b32 v62, v108, v104, s24
v_perm_b32 v108, v108, v104, s25
v_mov_b32 v104, v62
v_perm_b32 v62, v109, v105, s24
v_perm_b32 v109, v109, v105, s25
v_mov_b32 v105, v62
v_perm_b32 v62, v110, v106, s24
v_perm_b32 v110, v110, v106, s25
v_mov_b32 v106, v62
v_perm_b32 v62, v111, v107, s24
v_perm_b32 v111, v111, v107, s25
v_mov_b32 v107, v62
v_perm_b32 v62, v116, v112, s24
v_perm_b32 v116, v116, v112, s25
v_mov_b32 v112, v62
v_perm_b32 v62, v117, v113, s24
v_perm_b32 v117, v117, v113, s25
v_mov_b32 v113, v62
v_perm_b32 v62, v118, v114, s24
v_perm_b32 v118, v118, v114, s25
v_mov_b32 v114, v62
v_perm_b32 v62, v119, v115, s24
v_perm_b32 v119, v119, v115, s25
v_mov_b32 v115, v62
v_perm_b32 v62, v124, v120, s24
v_perm_b32 v124, v124, v120, s25
v_mov_b32 v120, v62
v_perm_b32 v62, v125, v121, s24
v_perm_b32 v125, v125, v121, s25
v_mov_b32 v121, v62
v_perm_b32 v62, v126, v122, s24
v_perm_b32 v126, v126, v122, s25
v_mov_b32 v122, v62
v_perm_b32 v62, v127, v123, s24
v_perm_b32 v127, v127, v123, s25
v_mov_b32 v123, v62
v_perm_b32 v62, v132, v128, s24
v_perm_b32 v132, v132, v128, s25
v_mov_b32 v128, v62
v_perm_b32 v62, v133, v129, s24
v_perm_b32 v133, v133, v129, s25
v_mov_b32 v129, v62
v_perm_b32 v62, v134, v130, s24
v_perm_b32 v134, v134, v130, s25
v_mov_b32 v130, v62
v_perm_b32 v62, v135, v131, s24
v_perm_b32 v135, v135, v131, s25
v_mov_b32 v131, v62
s_mul_i32 s27, s22, 40960
s_add_u32 s30, s27, 0
buffer_load_dwordx4 v[136:139], v15, s[8:11], s30 offen nt
s_add_u32 s30, s27, 1280
buffer_load_dwordx4 v[140:143], v15, s[8:11], s30 offen nt
s_add_u32 s30, s27, 2560
buffer_load_dwordx4 v[144:147], v15, s[8:11], s30 offen nt
s_add_u32 s30, s27, 3840
buffer_load_dwordx4 v[148:151], v15, s[8:11], s30 offen nt
s_add_u32 s30, s27, 5120
buffer_load_dwordx4 v[152:155], v15, s[8:11], s30 offen nt
s_add_u32 s30, s27, 6400
buffer_load_dwordx4 v[156:159], v15, s[8:11], s30 offen nt
s_add_u32 s30, s27, 7680
buffer_load_dwordx4 v[160:163], v15, s[8:11], s30 offen nt
s_add_u32 s30, s27, 8960
buffer_load_dwordx4 v[164:167], v15, s[8:11], s30 offen nt
s_add_u32 s30, s27, 10240
buffer_load_dwordx4 v[168:171], v15, s[8:11], s30 offen nt
s_add_u32 s30, s27, 11520
buffer_load_dwordx4 v[172:175], v15, s[8:11], s30 offen nt
s_add_u32 s30, s27, 12800
buffer_load_dwordx4 v[176:179], v15, s[8:11], s30 offen nt
s_add_u32 s30, s27, 14080
buffer_load_dwordx4 v[180:183], v15, s[8:11], s30 offen nt
s_mov_b32 s80, 0
v_mov_b32 v24, v208
v_mov_b32 v25, v210
v_mov_b32 v26, v212
v_mov_b32 v27, v214
v_mov_b32 v28, v216
v_mov_b32 v29, v218
v_mov_b32 v30, v220
v_mov_b32 v31, v222
v_mov_b32 v32, v224
v_mov_b32 v33, v226
v_mov_b32 v34, v228
v_mov_b32 v35, v230
v_add_f32 v32, 1.0, v32
v_add_f32 v33, 1.0, v33
v_add_f32 v34, 1.0, v34
v_add_f32 v35, 1.0, v35
v_lshlrev_b32 v36, 16, v16
v_and_b32 v37, 0xffff0000, v16
v_lshlrev_b32 v38, 16, v17
v_and_b32 v39, 0xffff0000, v17
v_lshlrev_b32 v8, 4, v7
s_mov_b32 s84, 786432
s_mov_b32 s85, 788992
s_mov_b32 s86, 791552
s_mov_b32 s87, 794112
s_mov_b32 s88, 796672
s_mov_b32 s89, 799232
s_mov_b32 s90, 801792
s_mov_b32 s91, 804352
s_lshl_b32 s30, s22, 9
s_add_u32 s30, s30, 655360
v_mov_b32 v62, 0
s_cmp_lg_u32 s21, 0
s_cbranch_scc1 L_xpw0
s_mov_b32 s26, 100000
g_9:
buffer_load_dwordx2 v[248:249], v62, s[4:7], s30 offen offset:0 sc1
s_waitcnt vmcnt(0)
v_xor_b32 v60, s20, v249
v_cmp_ne_u32 vcc, 0, v60
s_cbranch_vccz gd_10
s_sub_u32 s26, s26, 1
s_cmp_eq_u32 s26, 0
s_cbranch_scc1 gd_10
s_sleep 4
s_branch g_9
gd_10:
L_xpw0:
s_barrier
s_waitcnt vmcnt(0)
v_perm_b32 v62, v140, v136, s24
v_perm_b32 v140, v140, v136, s25
v_mov_b32 v136, v62
v_perm_b32 v62, v141, v137, s24
v_perm_b32 v141, v141, v137, s25
v_mov_b32 v137, v62
v_perm_b32 v62, v142, v138, s24
v_perm_b32 v142, v142, v138, s25
v_mov_b32 v138, v62
v_perm_b32 v62, v143, v139, s24
v_perm_b32 v143, v143, v139, s25
v_mov_b32 v139, v62
v_perm_b32 v62, v148, v144, s24
v_perm_b32 v148, v148, v144, s25
v_mov_b32 v144, v62
v_perm_b32 v62, v149, v145, s24
v_perm_b32 v149, v149, v145, s25
v_mov_b32 v145, v62
v_perm_b32 v62, v150, v146, s24
v_perm_b32 v150, v150, v146, s25
v_mov_b32 v146, v62
v_perm_b32 v62, v151, v147, s24
v_perm_b32 v151, v151, v147, s25
v_mov_b32 v147, v62
v_perm_b32 v62, v156, v152, s24
v_perm_b32 v156, v156, v152, s25
v_mov_b32 v152, v62
v_perm_b32 v62, v157, v153, s24
v_perm_b32 v157, v157, v153, s25
v_mov_b32 v153, v62
v_perm_b32 v62, v158, v154, s24
v_perm_b32 v158, v158, v154, s25
v_mov_b32 v154, v62
v_perm_b32 v62, v159, v155, s24
v_perm_b32 v159, v159, v155, s25
v_mov_b32 v155, v62
v_perm_b32 v62, v164, v160, s24
v_perm_b32 v164, v164, v160, s25
v_mov_b32 v160, v62
v_perm_b32 v62, v165, v161, s24
v_perm_b32 v165, v165, v161, s25
v_mov_b32 v161, v62
v_perm_b32 v62, v166, v162, s24
v_perm_b32 v166, v166, v162, s25
v_mov_b32 v162, v62
v_perm_b32 v62, v167, v163, s24
v_perm_b32 v167, v167, v163, s25
v_mov_b32 v163, v62
v_perm_b32 v62, v172, v168, s24
v_perm_b32 v172, v172, v168, s25
v_mov_b32 v168, v62
v_perm_b32 v62, v173, v169, s24
v_perm_b32 v173, v173, v169, s25
v_mov_b32 v169, v62
v_perm_b32 v62, v174, v170, s24
v_perm_b32 v174, v174, v170, s25
v_mov_b32 v170, v62
v_perm_b32 v62, v175, v171, s24
v_perm_b32 v175, v175, v171, s25
v_mov_b32 v171, v62
v_perm_b32 v62, v180, v176, s24
v_perm_b32 v180, v180, v176, s25
v_mov_b32 v176, v62
v_perm_b32 v62, v181, v177, s24
v_perm_b32 v181, v181, v177, s25
v_mov_b32 v177, v62
v_perm_b32 v62, v182, v178, s24
v_perm_b32 v182, v182, v178, s25
v_mov_b32 v178, v62
v_perm_b32 v62, v183, v179, s24
v_perm_b32 v183, v183, v179, s25
v_mov_b32 v179, v62
s_mov_b32 s26, 100000
g_11:
buffer_load_dwordx4 v[208:211], v8, s[4:7], s84 offen offset:0 sc1
buffer_load_dwordx4 v[212:215], v8, s[4:7], s85 offen offset:0 sc1
buffer_load_dwordx4 v[216:219], v8, s[4:7], s86 offen offset:0 sc1
buffer_load_dwordx4 v[220:223], v8, s[4:7], s87 offen offset:0 sc1
buffer_load_dwordx4 v[224:227], v8, s[4:7], s88 offen offset:0 sc1
buffer_load_dwordx4 v[228:231], v8, s[4:7], s89 offen offset:0 sc1
buffer_load_dwordx4 v[232:235], v8, s[4:7], s90 offen offset:0 sc1
buffer_load_dwordx4 v[236:239], v8, s[4:7], s91 offen offset:0 sc1
s_waitcnt vmcnt(0)
v_xor_b32 v60, s20, v209
v_xor_b32 v61, s20, v211
v_or_b32 v60, v60, v61
v_xor_b32 v61, s20, v213
v_or_b32 v60, v60, v61
v_xor_b32 v61, s20, v215
v_or_b32 v60, v60, v61
v_xor_b32 v61, s20, v217
v_or_b32 v60, v60, v61
v_xor_b32 v61, s20, v219
v_or_b32 v60, v60, v61
v_xor_b32 v61, s20, v221
v_or_b32 v60, v60, v61
v_xor_b32 v61, s20, v223
v_or_b32 v60, v60, v61
v_xor_b32 v61, s20, v225
v_or_b32 v60, v60, v61
v_xor_b32 v61, s20, v227
v_or_b32 v60, v60, v61
v_xor_b32 v61, s20, v229
v_or_b32 v60, v60, v61
v_xor_b32 v61, s20, v231
v_or_b32 v60, v60, v61
v_xor_b32 v61, s20, v233
v_or_b32 v60, v60, v61
v_xor_b32 v61, s20, v235
v_or_b32 v60, v60, v61
v_xor_b32 v61, s20, v237
v_or_b32 v60, v60, v61
v_xor_b32 v61, s20, v239
v_or_b32 v60, v60, v61
v_cmp_ne_u32 vcc, 0, v60
s_cbranch_vccz gd_12
s_sub_u32 s26, s26, 1
s_cmp_eq_u32 s26, 0
s_cbranch_scc1 gd_12
s_sleep 3
s_branch g_11
gd_12:
v_lshlrev_b32 v40, 16, v208
v_and_b32 v41, 0xffff0000, v208
v_lshlrev_b32 v42, 16, v210
v_and_b32 v43, 0xffff0000, v210
v_lshlrev_b32 v60, 16, v212
v_and_b32 v61, 0xffff0000, v212
v_add_f32 v40, v40, v60
v_add_f32 v41, v41, v61
v_lshlrev_b32 v60, 16, v214
v_and_b32 v61, 0xffff0000, v214
v_add_f32 v42, v42, v60
v_add_f32 v43, v43, v61
v_lshlrev_b32 v60, 16, v216
v_and_b32 v61, 0xffff0000, v216
v_add_f32 v40, v40, v60
v_add_f32 v41, v41, v61
v_lshlrev_b32 v60, 16, v218
v_and_b32 v61, 0xffff0000, v218
v_add_f32 v42, v42, v60
v_add_f32 v43, v43, v61
v_lshlrev_b32 v60, 16, v220
v_and_b32 v61, 0xffff0000, v220
v_add_f32 v40, v40, v60
v_add_f32 v41, v41, v61
v_lshlrev_b32 v60, 16, v222
v_and_b32 v61, 0xffff0000, v222
v_add_f32 v42, v42, v60
v_add_f32 v43, v43, v61
v_lshlrev_b32 v60, 16, v224
v_and_b32 v61, 0xffff0000, v224
v_add_f32 v40, v40, v60
v_add_f32 v41, v41, v61
v_lshlrev_b32 v60, 16, v226
v_and_b32 v61, 0xffff0000, v226
v_add_f32 v42, v42, v60
v_add_f32 v43, v43, v61
v_lshlrev_b32 v60, 16, v228
v_and_b32 v61, 0xffff0000, v228
v_add_f32 v40, v40, v60
v_add_f32 v41, v41, v61
v_lshlrev_b32 v60, 16, v230
v_and_b32 v61, 0xffff0000, v230
v_add_f32 v42, v42, v60
v_add_f32 v43, v43, v61
v_lshlrev_b32 v60, 16, v232
v_and_b32 v61, 0xffff0000, v232
v_add_f32 v40, v40, v60
v_add_f32 v41, v41, v61
v_lshlrev_b32 v60, 16, v234
v_and_b32 v61, 0xffff0000, v234
v_add_f32 v42, v42, v60
v_add_f32 v43, v43, v61
v_lshlrev_b32 v60, 16, v236
v_and_b32 v61, 0xffff0000, v236
v_add_f32 v40, v40, v60
v_add_f32 v41, v41, v61
v_lshlrev_b32 v60, 16, v238
v_and_b32 v61, 0xffff0000, v238
v_add_f32 v42, v42, v60
v_add_f32 v43, v43, v61
v_fmac_f32 v36, v24, v40
v_fmac_f32 v37, v25, v41
v_fmac_f32 v38, v26, v42
v_fmac_f32 v39, v27, v43
v_cmp_gt_u32 vcc, 160, v0
v_add_f32 v44, v36, v37
v_add_f32 v45, v38, v39
v_add_f32 v44, v44, v45
v_mul_f32 v45, v36, v36
v_fmac_f32 v45, v37, v37
v_fmac_f32 v45, v38, v38
v_fmac_f32 v45, v39, v39
v_cndmask_b32 v44, 0, v44, vcc
v_cndmask_b32 v45, 0, v45, vcc
s_nop 0
v_add_f32_dpp v44, v44, v44 row_ror:8 row_mask:0xf bank_mask:0xf
v_add_f32_dpp v45, v45, v45 row_ror:8 row_mask:0xf bank_mask:0xf
s_nop 0
v_add_f32_dpp v44, v44, v44 row_ror:4 row_mask:0xf bank_mask:0xf
v_add_f32_dpp v45, v45, v45 row_ror:4 row_mask:0xf bank_mask:0xf
s_nop 0
v_add_f32_dpp v44, v44, v44 row_ror:2 row_mask:0xf bank_mask:0xf
v_add_f32_dpp v45, v45, v45 row_ror:2 row_mask:0xf bank_mask:0xf
s_nop 0
v_add_f32_dpp v44, v44, v44 row_ror:1 row_mask:0xf bank_mask:0xf
v_add_f32_dpp v45, v45, v45 row_ror:1 row_mask:0xf bank_mask:0xf
v_lshlrev_b32 v46, 3, v3
ds_write_b64 v46, v[44:45] offset:24576
s_waitcnt lgkmcnt(0)
s_barrier
v_and_b32 v46, 15, v1
v_lshlrev_b32 v46, 3, v46
ds_read_b64 v[44:45], v46 offset:24576
s_waitcnt lgkmcnt(0)
s_nop 0
v_add_f32_dpp v44, v44, v44 row_ror:8 row_mask:0xf bank_mask:0xf
v_add_f32_dpp v45, v45, v45 row_ror:8 row_mask:0xf bank_mask:0xf
s_nop 0
v_add_f32_dpp v44, v44, v44 row_ror:4 row_mask:0xf bank_mask:0xf
v_add_f32_dpp v45, v45, v45 row_ror:4 row_mask:0xf bank_mask:0xf
s_nop 0
v_add_f32_dpp v44, v44, v44 row_ror:2 row_mask:0xf bank_mask:0xf
v_add_f32_dpp v45, v45, v45 row_ror:2 row_mask:0xf bank_mask:0xf
s_nop 0
v_add_f32_dpp v44, v44, v44 row_ror:1 row_mask:0xf bank_mask:0xf
v_add_f32_dpp v45, v45, v45 row_ror:1 row_mask:0xf bank_mask:0xf
v_mul_f32 v44, 0x3acccccd, v44
v_mul_f32 v45, 0x3acccccd, v45
v_fma_f32 v45, -v44, v44, v45
v_max_f32 v45, 0, v45
v_add_f32 v45, 0x3727c5ac, v45
v_rsq_f32 v45, v45
s_nop 0
v_sub_f32 v36, v36, v44
v_mul_f32 v36, v36, v45
v_fma_f32 v36, v36, v32, v28
v_sub_f32 v37, v37, v44
v_mul_f32 v37, v37, v45
v_fma_f32 v37, v37, v33, v29
v_sub_f32 v38, v38, v44
v_mul_f32 v38, v38, v45
v_fma_f32 v38, v38, v34, v30
v_sub_f32 v39, v39, v44
v_mul_f32 v39, v39, v45
v_fma_f32 v39, v39, v35, v31
v_cvt_pk_bf16_f32 v40, v36, v37
v_cvt_pk_bf16_f32 v41, v38, v39
v_lshlrev_b32 v33, 3, v7
ds_write_b64 v33, v[40:41] offset:8192
s_waitcnt lgkmcnt(0)
s_barrier
v_mul_u32_u24 v33, 20, v5
ds_read_b32 v40, v33 offset:8192
ds_read_b32 v41, v33 offset:8196
ds_read_b32 v42, v33 offset:8200
ds_read_b32 v43, v33 offset:8204
ds_read_b32 v44, v33 offset:8208
s_waitcnt lgkmcnt(0)
v_mov_b32 v20, 0
v_mov_b32 v21, 0
v_mov_b32 v22, 0
v_mov_b32 v23, 0
v_mov_b32 v24, 0
v_mov_b32 v25, 0
v_mov_b32 v26, 0
v_mov_b32 v27, 0
v_dot2c_f32_bf16 v20, v96, v40
v_dot2c_f32_bf16 v21, v100, v40
v_dot2c_f32_bf16 v22, v97, v40
v_dot2c_f32_bf16 v23, v101, v40
v_dot2c_f32_bf16 v24, v98, v40
v_dot2c_f32_bf16 v25, v102, v40
v_dot2c_f32_bf16 v26, v99, v40
v_dot2c_f32_bf16 v27, v103, v40
v_dot2c_f32_bf16 v20, v104, v41
v_dot2c_f32_bf16 v21, v108, v41
v_dot2c_f32_bf16 v22, v105, v41
v_dot2c_f32_bf16 v23, v109, v41
v_dot2c_f32_bf16 v24, v106, v41
v_dot2c_f32_bf16 v25, v110, v41
v_dot2c_f32_bf16 v26, v107, v41
v_dot2c_f32_bf16 v27, v111, v41
v_dot2c_f32_bf16 v20, v112, v42
v_dot2c_f32_bf16 v21, v116, v42
v_dot2c_f32_bf16 v22, v113, v42
v_dot2c_f32_bf16 v23, v117, v42
v_dot2c_f32_bf16 v24, v114, v42
v_dot2c_f32_bf16 v25, v118, v42
v_dot2c_f32_bf16 v26, v115, v42
v_dot2c_f32_bf16 v27, v119, v42
v_dot2c_f32_bf16 v20, v120, v43
v_dot2c_f32_bf16 v21, v124, v43
v_dot2c_f32_bf16 v22, v121, v43
v_dot2c_f32_bf16 v23, v125, v43
v_dot2c_f32_bf16 v24, v122, v43
v_dot2c_f32_bf16 v25, v126, v43
v_dot2c_f32_bf16 v26, v123, v43
v_dot2c_f32_bf16 v27, v127, v43
v_dot2c_f32_bf16 v20, v128, v44
v_dot2c_f32_bf16 v21, v132, v44
v_dot2c_f32_bf16 v22, v129, v44
v_dot2c_f32_bf16 v23, v133, v44
v_dot2c_f32_bf16 v24, v130, v44
v_dot2c_f32_bf16 v25, v134, v44
v_dot2c_f32_bf16 v26, v131, v44
v_dot2c_f32_bf16 v27, v135, v44
s_nop 2
v_add_f32_dpp v20, v20, v20 row_ror:4 row_mask:0xf bank_mask:0xf
v_add_f32_dpp v21, v21, v21 row_ror:4 row_mask:0xf bank_mask:0xf
v_add_f32_dpp v22, v22, v22 row_ror:4 row_mask:0xf bank_mask:0xf
v_add_f32_dpp v23, v23, v23 row_ror:4 row_mask:0xf bank_mask:0xf
v_add_f32_dpp v24, v24, v24 row_ror:4 row_mask:0xf bank_mask:0xf
v_add_f32_dpp v25, v25, v25 row_ror:4 row_mask:0xf bank_mask:0xf
v_add_f32_dpp v26, v26, v26 row_ror:4 row_mask:0xf bank_mask:0xf
v_add_f32_dpp v27, v27, v27 row_ror:4 row_mask:0xf bank_mask:0xf
v_add_f32_dpp v20, v20, v20 row_ror:8 row_mask:0xf bank_mask:0xf
v_add_f32_dpp v21, v21, v21 row_ror:8 row_mask:0xf bank_mask:0xf
v_add_f32_dpp v22, v22, v22 row_ror:8 row_mask:0xf bank_mask:0xf
v_add_f32_dpp v23, v23, v23 row_ror:8 row_mask:0xf bank_mask:0xf
v_add_f32_dpp v24, v24, v24 row_ror:8 row_mask:0xf bank_mask:0xf
v_add_f32_dpp v25, v25, v25 row_ror:8 row_mask:0xf bank_mask:0xf
v_add_f32_dpp v26, v26, v26 row_ror:8 row_mask:0xf bank_mask:0xf
v_add_f32_dpp v27, v27, v27 row_ror:8 row_mask:0xf bank_mask:0xf
v_lshrrev_b32 v33, 4, v0
v_mul_u32_u24 v33, 128, v33
v_and_b32 v61, 15, v0
v_lshl_add_u32 v33, v61, 5, v33
v_cmp_gt_u32 vcc, 4, v61
s_and_saveexec_b64 s[28:29], vcc
s_cbranch_execz skip_13
ds_write_b128 v33, v[20:23] offset:0
ds_write_b128 v33, v[24:27] offset:16
skip_13:
s_mov_b64 exec, s[28:29]
s_waitcnt lgkmcnt(0)
s_barrier
v_cmp_gt_u32 vcc, 16, v0
s_and_saveexec_b64 s[28:29], vcc
s_cbranch_execz skip_14
v_lshlrev_b32 v33, 3, v0
ds_read_b64 v[48:49], v33 offset:0
ds_read_b64 v[50:51], v33 offset:128
ds_read_b64 v[52:53], v33 offset:256
ds_read_b64 v[54:55], v33 offset:384
ds_read_b64 v[56:57], v33 offset:512
ds_read_b64 v[58:59], v33 offset:640
ds_read_b64 v[60:61], v33 offset:768
ds_read_b64 v[62:63], v33 offset:896
ds_read_b64 v[64:65], v33 offset:1024
ds_read_b64 v[66:67], v33 offset:1152
ds_read_b64 v[68:69], v33 offset:1280
ds_read_b64 v[70:71], v33 offset:1408
ds_read_b64 v[72:73], v33 offset:1536
ds_read_b64 v[74:75], v33 offset:1664
ds_read_b64 v[76:77], v33 offset:1792
ds_read_b64 v[78:79], v33 offset:1920
s_waitcnt lgkmcnt(0)
v_pk_add_f32 v[48:49], v[48:49], v[64:65]
v_pk_add_f32 v[50:51], v[50:51], v[66:67]
v_pk_add_f32 v[52:53], v[52:53], v[68:69]
v_pk_add_f32 v[54:55], v[54:55], v[70:71]
v_pk_add_f32 v[56:57], v[56:57], v[72:73]
v_pk_add_f32 v[58:59], v[58:59], v[74:75]
v_pk_add_f32 v[60:61], v[60:61], v[76:77]
v_pk_add_f32 v[62:63], v[62:63], v[78:79]
v_pk_add_f32 v[48:49], v[48:49], v[56:57]
v_pk_add_f32 v[50:51], v[50:51], v[58:59]
v_pk_add_f32 v[52:53], v[52:53], v[60:61]
v_pk_add_f32 v[54:55], v[54:55], v[62:63]
v_pk_add_f32 v[48:49], v[48:49], v[52:53]
v_pk_add_f32 v[50:51], v[50:51], v[54:55]
v_pk_add_f32 v[48:49], v[48:49], v[50:51]
v_mov_b32 v40, v48
v_mov_b32 v41, v49
v_max_f32 v40, 0, v40
v_max_f32 v41, 0, v41
v_cvt_pk_bf16_f32 v40, v40, v41
v_lshlrev_b32 v33, 2, v0
ds_write_b32 v33, v40 offset:12288
skip_14:
s_mov_b64 exec, s[28:29]
s_waitcnt lgkmcnt(0)
s_barrier
v_mul_u32_u24 v33, 24, v13
ds_read_b64 v[40:41], v33 offset:12288
ds_read_b64 v[42:43], v33 offset:12296
ds_read_b64 v[44:45], v33 offset:12304
s_waitcnt lgkmcnt(0)
v_mov_b32 v20, 0
v_mov_b32 v21, 0
v_mov_b32 v22, 0
v_mov_b32 v23, 0
v_mov_b32 v24, 0
v_mov_b32 v25, 0
v_mov_b32 v26, 0
v_mov_b32 v27, 0
v_dot2c_f32_bf16 v20, v136, v40
v_dot2c_f32_bf16 v21, v140, v40
v_dot2c_f32_bf16 v22, v137, v40
v_dot2c_f32_bf16 v23, v141, v40
v_dot2c_f32_bf16 v24, v138, v40
v_dot2c_f32_bf16 v25, v142, v40
v_dot2c_f32_bf16 v26, v139, v40
v_dot2c_f32_bf16 v27, v143, v40
v_dot2c_f32_bf16 v20, v144, v41
v_dot2c_f32_bf16 v21, v148, v41
v_dot2c_f32_bf16 v22, v145, v41
v_dot2c_f32_bf16 v23, v149, v41
v_dot2c_f32_bf16 v24, v146, v41
v_dot2c_f32_bf16 v25, v150, v41
v_dot2c_f32_bf16 v26, v147, v41
v_dot2c_f32_bf16 v27, v151, v41
v_dot2c_f32_bf16 v20, v152, v42
v_dot2c_f32_bf16 v21, v156, v42
v_dot2c_f32_bf16 v22, v153, v42
v_dot2c_f32_bf16 v23, v157, v42
v_dot2c_f32_bf16 v24, v154, v42
v_dot2c_f32_bf16 v25, v158, v42
v_dot2c_f32_bf16 v26, v155, v42
v_dot2c_f32_bf16 v27, v159, v42
v_dot2c_f32_bf16 v20, v160, v43
v_dot2c_f32_bf16 v21, v164, v43
v_dot2c_f32_bf16 v22, v161, v43
v_dot2c_f32_bf16 v23, v165, v43
v_dot2c_f32_bf16 v24, v162, v43
v_dot2c_f32_bf16 v25, v166, v43
v_dot2c_f32_bf16 v26, v163, v43
v_dot2c_f32_bf16 v27, v167, v43
v_dot2c_f32_bf16 v20, v168, v44
v_dot2c_f32_bf16 v21, v172, v44
v_dot2c_f32_bf16 v22, v169, v44
v_dot2c_f32_bf16 v23, v173, v44
v_dot2c_f32_bf16 v24, v170, v44
v_dot2c_f32_bf16 v25, v174, v44
v_dot2c_f32_bf16 v26, v171, v44
v_dot2c_f32_bf16 v27, v175, v44
v_dot2c_f32_bf16 v20, v176, v45
v_dot2c_f32_bf16 v21, v180, v45
v_dot2c_f32_bf16 v22, v177, v45
v_dot2c_f32_bf16 v23, v181, v45
v_dot2c_f32_bf16 v24, v178, v45
v_dot2c_f32_bf16 v25, v182, v45
v_dot2c_f32_bf16 v26, v179, v45
v_dot2c_f32_bf16 v27, v183, v45
s_nop 2
v_cmp_gt_u32 vcc, 240, v0
s_and_saveexec_b64 s[28:29], vcc
s_cbranch_execz skip_15
v_mul_u32_u24 v33, 2560, v13
v_lshl_add_u32 v33, v14, 5, v33
ds_write_b128 v33, v[20:23] offset:16384
ds_write_b128 v33, v[24:27] offset:16400
skip_15:
s_mov_b64 exec, s[28:29]
s_waitcnt lgkmcnt(0)
s_barrier
v_cmp_gt_u32 vcc, 160, v0
s_and_saveexec_b64 s[28:29], vcc
s_cbranch_execz skip_16
v_lshlrev_b32 v33, 4, v0
ds_read_b128 v[40:43], v33 offset:16384
ds_read_b128 v[44:47], v33 offset:18944
ds_read_b128 v[48:51], v33 offset:21504
s_waitcnt lgkmcnt(0)
v_add_f32 v40, v40, v44
v_add_f32 v40, v40, v48
v_add_f32 v41, v41, v45
v_add_f32 v41, v41, v49
v_add_f32 v42, v42, v46
v_add_f32 v42, v42, v50
v_add_f32 v43, v43, v47
v_add_f32 v43, v43, v51
v_mov_b32 v52, v40
v_mov_b32 v53, s20
v_mov_b32 v54, v41
v_mov_b32 v55, s20
v_mov_b32 v56, v42
v_mov_b32 v57, s20
v_mov_b32 v58, v43
v_mov_b32 v59, s20
s_mul_i32 s27, s22, 5120
s_add_u32 s27, s27, 1048576
v_lshlrev_b32 v33, 5, v0
buffer_store_dwordx4 v[52:55], v33, s[4:7], s27 offen sc1
buffer_store_dwordx4 v[56:59], v33, s[4:7], s27 offen offset:16 sc1
skip_16:
s_mov_b64 exec, s[28:29]
s_branch L_end
L_notP7:
s_cmp_lt_u32 s22, 64
s_cbranch_scc1 L_end
s_cmp_ge_u32 s22, 84
s_cbranch_scc1 L_end
s_sub_u32 s33, s22, 64
s_mov_b32 s12, s36
s_mov_b32 s13, s37
s_mov_b32 s14, 0x500
s_mov_b32 s15, 0x20000
s_mov_b32 s16, s58
s_mov_b32 s17, s59
s_mov_b32 s18, 0x500
s_mov_b32 s19, 0x20000
v_lshlrev_b32 v9, 2, v4
s_lshl_b32 s27, s33, 6
buffer_load_dword v16, v9, s[12:15], s27 offen
v_lshlrev_b32 v9, 4, v4
s_lshl_b32 s27, s33, 8
s_add_u32 s84, s27, 393216
s_add_u32 s85, s27, 408576
s_mov_b32 s26, 100000
g_17:
buffer_load_dwordx4 v[208:211], v9, s[4:7], s84 offen offset:0 sc1
buffer_load_dwordx4 v[212:215], v9, s[4:7], s85 offen offset:0 sc1
s_waitcnt vmcnt(0)
v_xor_b32 v60, s20, v209
v_xor_b32 v61, s20, v211
v_or_b32 v60, v60, v61
v_xor_b32 v61, s20, v213
v_or_b32 v60, v60, v61
v_xor_b32 v61, s20, v215
v_or_b32 v60, v60, v61
v_cmp_ne_u32 vcc, 0, v60
s_cbranch_vccz gd_18
s_sub_u32 s26, s26, 1
s_cmp_eq_u32 s26, 0
s_cbranch_scc1 gd_18
s_sleep 1
s_branch g_17
gd_18:
v_mov_b32 v24, v208
v_mov_b32 v25, v210
v_mov_b32 v26, v212
v_mov_b32 v27, v214
v_lshlrev_b32 v9, 3, v4
s_lshl_b32 s27, s33, 7
s_add_u32 s84, s27, 786432
s_add_u32 s85, s27, 788992
s_add_u32 s86, s27, 791552
s_add_u32 s87, s27, 794112
s_add_u32 s88, s27, 796672
s_add_u32 s89, s27, 799232
s_add_u32 s90, s27, 801792
s_add_u32 s91, s27, 804352
s_cmp_lg_u32 s21, 0
s_cbranch_scc1 pw0_19
s_mov_b32 s26, 100000
gp_20:
buffer_load_dwordx2 v[208:209], v9, s[4:7], s84 offen offset:0 sc1
s_waitcnt vmcnt(0)
v_xor_b32 v60, s20, v209
v_cmp_ne_u32 vcc, 0, v60
s_cbranch_vccz gpd_21
s_sub_u32 s26, s26, 1
s_cmp_eq_u32 s26, 0
s_cbranch_scc1 gpd_21
s_sleep 4
s_branch gp_20
gpd_21:
pw0_19:
s_barrier
s_mov_b32 s26, 100000
g_22:
buffer_load_dwordx2 v[208:209], v9, s[4:7], s84 offen offset:0 sc1
buffer_load_dwordx2 v[210:211], v9, s[4:7], s85 offen offset:0 sc1
buffer_load_dwordx2 v[212:213], v9, s[4:7], s86 offen offset:0 sc1
buffer_load_dwordx2 v[214:215], v9, s[4:7], s87 offen offset:0 sc1
buffer_load_dwordx2 v[216:217], v9, s[4:7], s88 offen offset:0 sc1
buffer_load_dwordx2 v[218:219], v9, s[4:7], s89 offen offset:0 sc1
buffer_load_dwordx2 v[220:221], v9, s[4:7], s90 offen offset:0 sc1
buffer_load_dwordx2 v[222:223], v9, s[4:7], s91 offen offset:0 sc1
s_waitcnt vmcnt(0)
v_xor_b32 v60, s20, v209
v_xor_b32 v61, s20, v211
v_or_b32 v60, v60, v61
v_xor_b32 v61, s20, v213
v_or_b32 v60, v60, v61
v_xor_b32 v61, s20, v215
v_or_b32 v60, v60, v61
v_xor_b32 v61, s20, v217
v_or_b32 v60, v60, v61
v_xor_b32 v61, s20, v219
v_or_b32 v60, v60, v61
v_xor_b32 v61, s20, v221
v_or_b32 v60, v60, v61
v_xor_b32 v61, s20, v223
v_or_b32 v60, v60, v61
v_cmp_ne_u32 vcc, 0, v60
s_cbranch_vccz gd_23
s_sub_u32 s26, s26, 1
s_cmp_eq_u32 s26, 0
s_cbranch_scc1 gd_23
s_sleep 3
s_branch g_22
gd_23:
v_lshlrev_b32 v40, 16, v208
v_and_b32 v41, 0xffff0000, v208
v_lshlrev_b32 v60, 16, v210
v_and_b32 v61, 0xffff0000, v210
v_add_f32 v40, v40, v60
v_add_f32 v41, v41, v61
v_lshlrev_b32 v60, 16, v212
v_and_b32 v61, 0xffff0000, v212
v_add_f32 v40, v40, v60
v_add_f32 v41, v41, v61
v_lshlrev_b32 v60, 16, v214
v_and_b32 v61, 0xffff0000, v214
v_add_f32 v40, v40, v60
v_add_f32 v41, v41, v61
v_lshlrev_b32 v60, 16, v216
v_and_b32 v61, 0xffff0000, v216
v_add_f32 v40, v40, v60
v_add_f32 v41, v41, v61
v_lshlrev_b32 v60, 16, v218
v_and_b32 v61, 0xffff0000, v218
v_add_f32 v40, v40, v60
v_add_f32 v41, v41, v61
v_lshlrev_b32 v60, 16, v220
v_and_b32 v61, 0xffff0000, v220
v_add_f32 v40, v40, v60
v_add_f32 v41, v41, v61
v_lshlrev_b32 v60, 16, v222
v_and_b32 v61, 0xffff0000, v222
v_add_f32 v40, v40, v60
v_add_f32 v41, v41, v61
v_lshlrev_b32 v28, 16, v16
v_and_b32 v29, 0xffff0000, v16
v_fmac_f32 v28, v24, v40
v_fmac_f32 v29, v25, v41
v_add_u32 v10, 0, v3
v_min_u32 v10, 53, v10
v_mul_u32_u24 v10, 5120, v10
v_lshl_add_u32 v10, v4, 4, v10
v_add_u32 v11, 16, v3
v_min_u32 v11, 53, v11
v_mul_u32_u24 v11, 5120, v11
v_lshl_add_u32 v11, v4, 4, v11
v_add_u32 v12, 32, v3
v_min_u32 v12, 53, v12
v_mul_u32_u24 v12, 5120, v12
v_lshl_add_u32 v12, v4, 4, v12
v_add_u32 v13, 48, v3
v_min_u32 v13, 53, v13
v_mul_u32_u24 v13, 5120, v13
v_lshl_add_u32 v13, v4, 4, v13
s_lshl_b32 s27, s33, 8
s_add_u32 s27, s27, 1048576
s_mov_b32 s26, 100000
g_24:
buffer_load_dwordx4 v[224:227], v10, s[4:7], s27 offen offset:0 sc1
buffer_load_dwordx4 v[228:231], v11, s[4:7], s27 offen offset:0 sc1
buffer_load_dwordx4 v[232:235], v12, s[4:7], s27 offen offset:0 sc1
buffer_load_dwordx4 v[236:239], v13, s[4:7], s27 offen offset:0 sc1
s_waitcnt vmcnt(0)
v_xor_b32 v60, s20, v225
v_xor_b32 v61, s20, v227
v_or_b32 v60, v60, v61
v_xor_b32 v61, s20, v229
v_or_b32 v60, v60, v61
v_xor_b32 v61, s20, v231
v_or_b32 v60, v60, v61
v_xor_b32 v61, s20, v233
v_or_b32 v60, v60, v61
v_xor_b32 v61, s20, v235
v_or_b32 v60, v60, v61
v_xor_b32 v61, s20, v237
v_or_b32 v60, v60, v61
v_xor_b32 v61, s20, v239
v_or_b32 v60, v60, v61
v_cmp_ne_u32 vcc, 0, v60
s_cbranch_vccz gd_25
s_sub_u32 s26, s26, 1
s_cmp_eq_u32 s26, 0
s_cbranch_scc1 gd_25
s_sleep 3
s_branch g_24
gd_25:
v_cmp_gt_u32 vcc, 6, v3
v_add_f32 v40, v224, v228
v_add_f32 v41, v226, v230
v_add_f32 v40, v40, v232
v_add_f32 v41, v41, v234
v_cndmask_b32 v42, 0, v236, vcc
v_cndmask_b32 v43, 0, v238, vcc
v_add_f32 v40, v40, v42
v_add_f32 v41, v41, v43
v_lshlrev_b32 v33, 3, v0
ds_write_b64 v33, v[40:41]
s_waitcnt lgkmcnt(0)
s_barrier
v_cmp_gt_u32 vcc, 16, v0
s_and_saveexec_b64 s[28:29], vcc
s_cbranch_execz skip_26
v_lshlrev_b32 v33, 3, v0
ds_read_b64 v[48:49], v33 offset:0
ds_read_b64 v[50:51], v33 offset:128
ds_read_b64 v[52:53], v33 offset:256
ds_read_b64 v[54:55], v33 offset:384
ds_read_b64 v[56:57], v33 offset:512
ds_read_b64 v[58:59], v33 offset:640
ds_read_b64 v[60:61], v33 offset:768
ds_read_b64 v[62:63], v33 offset:896
ds_read_b64 v[64:65], v33 offset:1024
ds_read_b64 v[66:67], v33 offset:1152
ds_read_b64 v[68:69], v33 offset:1280
ds_read_b64 v[70:71], v33 offset:1408
ds_read_b64 v[72:73], v33 offset:1536
ds_read_b64 v[74:75], v33 offset:1664
ds_read_b64 v[76:77], v33 offset:1792
ds_read_b64 v[78:79], v33 offset:1920
s_waitcnt lgkmcnt(0)
v_pk_add_f32 v[48:49], v[48:49], v[64:65]
v_pk_add_f32 v[50:51], v[50:51], v[66:67]
v_pk_add_f32 v[52:53], v[52:53], v[68:69]
v_pk_add_f32 v[54:55], v[54:55], v[70:71]
v_pk_add_f32 v[56:57], v[56:57], v[72:73]
v_pk_add_f32 v[58:59], v[58:59], v[74:75]
v_pk_add_f32 v[60:61], v[60:61], v[76:77]
v_pk_add_f32 v[62:63], v[62:63], v[78:79]
v_pk_add_f32 v[48:49], v[48:49], v[56:57]
v_pk_add_f32 v[50:51], v[50:51], v[58:59]
v_pk_add_f32 v[52:53], v[52:53], v[60:61]
v_pk_add_f32 v[54:55], v[54:55], v[62:63]
v_pk_add_f32 v[48:49], v[48:49], v[52:53]
v_pk_add_f32 v[50:51], v[50:51], v[54:55]
v_pk_add_f32 v[48:49], v[48:49], v[50:51]
v_mov_b32 v40, v48
v_mov_b32 v41, v49
v_fmac_f32 v28, v26, v40
v_fmac_f32 v29, v27, v41
v_cvt_pk_bf16_f32 v28, v28, v29
v_lshlrev_b32 v38, 2, v0
s_lshl_b32 s27, s33, 6
buffer_store_dword v28, v38, s[16:19], s27 offen
skip_26:
s_mov_b64 exec, s[28:29]
s_cmp_lg_u32 s33, 0
s_cbranch_scc1 L_end
v_cmp_gt_u32 vcc, 1, v0
s_and_saveexec_b64 s[28:29], vcc
s_cbranch_execz skip_27
v_mov_b32 v2, 0
v_mov_b32 v3, s20
buffer_store_dword v3, v2, s[4:7], 0 offen sc1
skip_27:
s_mov_b64 exec, s[28:29]
s_branch L_end
s_branch L_end
L_Wrest:
s_waitcnt vmcnt(8)
v_perm_b32 v62, v68, v64, s24
v_perm_b32 v68, v68, v64, s25
v_mov_b32 v64, v62
v_perm_b32 v62, v69, v65, s24
v_perm_b32 v69, v69, v65, s25
v_mov_b32 v65, v62
v_perm_b32 v62, v70, v66, s24
v_perm_b32 v70, v70, v66, s25
v_mov_b32 v66, v62
v_perm_b32 v62, v71, v67, s24
v_perm_b32 v71, v71, v67, s25
v_mov_b32 v67, v62
v_perm_b32 v62, v76, v72, s24
v_perm_b32 v76, v76, v72, s25
v_mov_b32 v72, v62
v_perm_b32 v62, v77, v73, s24
v_perm_b32 v77, v77, v73, s25
v_mov_b32 v73, v62
v_perm_b32 v62, v78, v74, s24
v_perm_b32 v78, v78, v74, s25
v_mov_b32 v74, v62
v_perm_b32 v62, v79, v75, s24
v_perm_b32 v79, v79, v75, s25
v_mov_b32 v75, v62
v_perm_b32 v62, v84, v80, s24
v_perm_b32 v84, v84, v80, s25
v_mov_b32 v80, v62
v_perm_b32 v62, v85, v81, s24
v_perm_b32 v85, v85, v81, s25
v_mov_b32 v81, v62
v_perm_b32 v62, v86, v82, s24
v_perm_b32 v86, v86, v82, s25
v_mov_b32 v82, v62
v_perm_b32 v62, v87, v83, s24
v_perm_b32 v87, v87, v83, s25
v_mov_b32 v83, v62
v_perm_b32 v62, v92, v88, s24
v_perm_b32 v92, v92, v88, s25
v_mov_b32 v88, v62
v_perm_b32 v62, v93, v89, s24
v_perm_b32 v93, v93, v89, s25
v_mov_b32 v89, v62
v_perm_b32 v62, v94, v90, s24
v_perm_b32 v94, v94, v90, s25
v_mov_b32 v90, v62
v_perm_b32 v62, v95, v91, s24
v_perm_b32 v95, v95, v91, s25
v_mov_b32 v91, v62
v_perm_b32 v62, v100, v96, s24
v_perm_b32 v100, v100, v96, s25
v_mov_b32 v96, v62
v_perm_b32 v62, v101, v97, s24
v_perm_b32 v101, v101, v97, s25
v_mov_b32 v97, v62
v_perm_b32 v62, v102, v98, s24
v_perm_b32 v102, v102, v98, s25
v_mov_b32 v98, v62
v_perm_b32 v62, v103, v99, s24
v_perm_b32 v103, v103, v99, s25
v_mov_b32 v99, v62
s_mov_b32 s80, 0
s_cmp_ge_u32 s21, 2
s_cbranch_scc1 L_p2_nog
v_cmp_gt_u32 vcc, 80, v0
s_and_saveexec_b64 s[28:29], vcc
s_cbranch_execz skip_29
v_lshlrev_b32 v33, 4, v0
s_mul_i32 s27, s32, 1280
s_add_u32 s27, s27, 4096
s_add_u32 s84, s27, 0
s_add_u32 s85, s27, 5120
s_add_u32 s86, s27, 10240
s_add_u32 s87, s27, 15360
s_add_u32 s88, s27, 20480
s_add_u32 s89, s27, 25600
s_add_u32 s90, s27, 30720
s_add_u32 s91, s27, 35840
s_add_u32 s92, s27, 40960
s_add_u32 s93, s27, 46080
s_mov_b32 s26, 100000
gp_30:
buffer_load_dwordx4 v[184:187], v33, s[4:7], s84 offen offset:0 sc1
s_waitcnt vmcnt(0)
v_xor_b32 v60, s20, v185
v_xor_b32 v61, s20, v187
v_or_b32 v60, v60, v61
v_cmp_ne_u32 vcc, 0, v60
s_cbranch_vccz gpd_31
s_sub_u32 s26, s26, 1
s_cmp_eq_u32 s26, 0
s_cbranch_scc1 gpd_31
s_sleep 3
s_branch gp_30
gpd_31:
s_mov_b32 s26, 100000
g_32:
buffer_load_dwordx4 v[184:187], v33, s[4:7], s84 offen offset:0 sc1
buffer_load_dwordx4 v[188:191], v33, s[4:7], s85 offen offset:0 sc1
buffer_load_dwordx4 v[192:195], v33, s[4:7], s86 offen offset:0 sc1
buffer_load_dwordx4 v[196:199], v33, s[4:7], s87 offen offset:0 sc1
buffer_load_dwordx4 v[200:203], v33, s[4:7], s88 offen offset:0 sc1
buffer_load_dwordx4 v[204:207], v33, s[4:7], s89 offen offset:0 sc1
buffer_load_dwordx4 v[208:211], v33, s[4:7], s90 offen offset:0 sc1
buffer_load_dwordx4 v[212:215], v33, s[4:7], s91 offen offset:0 sc1
buffer_load_dwordx4 v[216:219], v33, s[4:7], s92 offen offset:0 sc1
buffer_load_dwordx4 v[220:223], v33, s[4:7], s93 offen offset:0 sc1
s_waitcnt vmcnt(0)
v_xor_b32 v60, s20, v185
v_xor_b32 v61, s20, v187
v_or_b32 v60, v60, v61
v_xor_b32 v61, s20, v189
v_or_b32 v60, v60, v61
v_xor_b32 v61, s20, v191
v_or_b32 v60, v60, v61
v_xor_b32 v61, s20, v193
v_or_b32 v60, v60, v61
v_xor_b32 v61, s20, v195
v_or_b32 v60, v60, v61
v_xor_b32 v61, s20, v197
v_or_b32 v60, v60, v61
v_xor_b32 v61, s20, v199
v_or_b32 v60, v60, v61
v_xor_b32 v61, s20, v201
v_or_b32 v60, v60, v61
v_xor_b32 v61, s20, v203
v_or_b32 v60, v60, v61
v_xor_b32 v61, s20, v205
v_or_b32 v60, v60, v61
v_xor_b32 v61, s20, v207
v_or_b32 v60, v60, v61
v_xor_b32 v61, s20, v209
v_or_b32 v60, v60, v61
v_xor_b32 v61, s20, v211
v_or_b32 v60, v60, v61
v_xor_b32 v61, s20, v213
v_or_b32 v60, v60, v61
v_xor_b32 v61, s20, v215
v_or_b32 v60, v60, v61
v_xor_b32 v61, s20, v217
v_or_b32 v60, v60, v61
v_xor_b32 v61, s20, v219
v_or_b32 v60, v60, v61
v_xor_b32 v61, s20, v221
v_or_b32 v60, v60, v61
v_xor_b32 v61, s20, v223
v_or_b32 v60, v60, v61
v_cmp_ne_u32 vcc, 0, v60
s_cbranch_vccz gd_33
s_sub_u32 s26, s26, 1
s_cmp_eq_u32 s26, 0
s_cbranch_scc1 gd_33
s_sleep 3
s_branch g_32
gd_33:
v_add_f32 v144, v184, v188
v_add_f32 v144, v144, v192
v_add_f32 v144, v144, v196
v_add_f32 v144, v144, v200
v_add_f32 v144, v144, v204
v_add_f32 v144, v144, v208
v_add_f32 v144, v144, v212
v_add_f32 v144, v144, v216
v_add_f32 v144, v144, v220
v_add_f32 v146, v186, v190
v_add_f32 v146, v146, v194
v_add_f32 v146, v146, v198
v_add_f32 v146, v146, v202
v_add_f32 v146, v146, v206
v_add_f32 v146, v146, v210
v_add_f32 v146, v146, v214
v_add_f32 v146, v146, v218
v_add_f32 v146, v146, v222
v_cvt_pk_bf16_f32 v40, v144, v146
v_lshlrev_b32 v33, 2, v0
ds_write_b32 v33, v40 offset:8192
skip_29:
s_mov_b64 exec, s[28:29]
L_p2_nog:
s_waitcnt lgkmcnt(0)
s_barrier
v_mul_u32_u24 v33, 20, v3
ds_read_b32 v40, v33 offset:8192
ds_read_b32 v41, v33 offset:8196
ds_read_b32 v42, v33 offset:8200
ds_read_b32 v43, v33 offset:8204
ds_read_b32 v44, v33 offset:8208
s_waitcnt lgkmcnt(0)
v_mov_b32 v20, 0
v_mov_b32 v21, 0
v_mov_b32 v22, 0
v_mov_b32 v23, 0
v_mov_b32 v24, 0
v_mov_b32 v25, 0
v_mov_b32 v26, 0
v_mov_b32 v27, 0
v_dot2c_f32_bf16 v20, v64, v40
v_dot2c_f32_bf16 v21, v68, v40
v_dot2c_f32_bf16 v22, v65, v40
v_dot2c_f32_bf16 v23, v69, v40
v_dot2c_f32_bf16 v24, v66, v40
v_dot2c_f32_bf16 v25, v70, v40
v_dot2c_f32_bf16 v26, v67, v40
v_dot2c_f32_bf16 v27, v71, v40
v_dot2c_f32_bf16 v20, v72, v41
v_dot2c_f32_bf16 v21, v76, v41
v_dot2c_f32_bf16 v22, v73, v41
v_dot2c_f32_bf16 v23, v77, v41
v_dot2c_f32_bf16 v24, v74, v41
v_dot2c_f32_bf16 v25, v78, v41
v_dot2c_f32_bf16 v26, v75, v41
v_dot2c_f32_bf16 v27, v79, v41
v_dot2c_f32_bf16 v20, v80, v42
v_dot2c_f32_bf16 v21, v84, v42
v_dot2c_f32_bf16 v22, v81, v42
v_dot2c_f32_bf16 v23, v85, v42
v_dot2c_f32_bf16 v24, v82, v42
v_dot2c_f32_bf16 v25, v86, v42
v_dot2c_f32_bf16 v26, v83, v42
v_dot2c_f32_bf16 v27, v87, v42
v_dot2c_f32_bf16 v20, v88, v43
v_dot2c_f32_bf16 v21, v92, v43
v_dot2c_f32_bf16 v22, v89, v43
v_dot2c_f32_bf16 v23, v93, v43
v_dot2c_f32_bf16 v24, v90, v43
v_dot2c_f32_bf16 v25, v94, v43
v_dot2c_f32_bf16 v26, v91, v43
v_dot2c_f32_bf16 v27, v95, v43
v_dot2c_f32_bf16 v20, v96, v44
v_dot2c_f32_bf16 v21, v100, v44
v_dot2c_f32_bf16 v22, v97, v44
v_dot2c_f32_bf16 v23, v101, v44
v_dot2c_f32_bf16 v24, v98, v44
v_dot2c_f32_bf16 v25, v102, v44
v_dot2c_f32_bf16 v26, v99, v44
v_dot2c_f32_bf16 v27, v103, v44
s_nop 2
v_lshrrev_b32 v33, 4, v0
v_mul_u32_u24 v33, 512, v33
v_and_b32 v61, 15, v0
v_lshl_add_u32 v33, v61, 5, v33
ds_write_b128 v33, v[20:23] offset:0
ds_write_b128 v33, v[24:27] offset:16
s_waitcnt lgkmcnt(0)
s_barrier
v_cmp_gt_u32 vcc, 64, v0
s_and_saveexec_b64 s[28:29], vcc
s_cbranch_execz skip_34
v_lshlrev_b32 v33, 3, v0
ds_read_b64 v[144:145], v33 offset:0
ds_read_b64 v[146:147], v33 offset:512
ds_read_b64 v[148:149], v33 offset:1024
ds_read_b64 v[150:151], v33 offset:1536
ds_read_b64 v[152:153], v33 offset:2048
ds_read_b64 v[154:155], v33 offset:2560
ds_read_b64 v[156:157], v33 offset:3072
ds_read_b64 v[158:159], v33 offset:3584
ds_read_b64 v[160:161], v33 offset:4096
ds_read_b64 v[162:163], v33 offset:4608
ds_read_b64 v[164:165], v33 offset:5120
ds_read_b64 v[166:167], v33 offset:5632
ds_read_b64 v[168:169], v33 offset:6144
ds_read_b64 v[170:171], v33 offset:6656
ds_read_b64 v[172:173], v33 offset:7168
ds_read_b64 v[174:175], v33 offset:7680
s_waitcnt lgkmcnt(0)
v_pk_add_f32 v[144:145], v[144:145], v[160:161]
v_pk_add_f32 v[146:147], v[146:147], v[162:163]
v_pk_add_f32 v[148:149], v[148:149], v[164:165]
v_pk_add_f32 v[150:151], v[150:151], v[166:167]
v_pk_add_f32 v[152:153], v[152:153], v[168:169]
v_pk_add_f32 v[154:155], v[154:155], v[170:171]
v_pk_add_f32 v[156:157], v[156:157], v[172:173]
v_pk_add_f32 v[158:159], v[158:159], v[174:175]
v_pk_add_f32 v[144:145], v[144:145], v[152:153]
v_pk_add_f32 v[146:147], v[146:147], v[154:155]
v_pk_add_f32 v[148:149], v[148:149], v[156:157]
v_pk_add_f32 v[150:151], v[150:151], v[158:159]
v_pk_add_f32 v[144:145], v[144:145], v[148:149]
v_pk_add_f32 v[146:147], v[146:147], v[150:151]
v_pk_add_f32 v[144:145], v[144:145], v[146:147]
v_mov_b32 v40, v144
v_mov_b32 v41, v145
v_mov_b32 v44, v40
v_mov_b32 v45, s20
v_mov_b32 v46, v41
v_mov_b32 v47, s20
s_lshl_b32 s27, s101, 10
s_add_u32 s27, s27, 65536
v_lshlrev_b32 v33, 4, v0
s_add_u32 s30, s27, 8388608
buffer_store_dwordx4 v[44:47], v33, s[4:7], s30 offen
buffer_store_dwordx4 v[44:47], v33, s[4:7], s27 offen sc1
skip_34:
s_mov_b64 exec, s[28:29]
v_lshlrev_b32 v33, 4, v0
s_lshl_b32 s27, s31, 12
s_add_u32 s27, s27, 65536
s_mov_b32 s26, 100000
s_add_u32 s88, s27, 8388608
g2_35:
s_mov_b32 s35, 8
g2l_38:
buffer_load_dwordx4 v[228:231], v33, s[4:7], s88 offen offset:0 sc1
s_waitcnt vmcnt(0)
v_xor_b32 v60, s20, v229
v_xor_b32 v61, s20, v231
v_or_b32 v60, v60, v61
v_cmp_ne_u32 vcc, 0, v60
s_cbranch_vccz g2f_36
s_sub_u32 s35, s35, 1
s_cmp_lg_u32 s35, 0
s_cbranch_scc1 g2l_38
buffer_load_dwordx4 v[224:227], v33, s[4:7], s27 offen offset:0 sc1
s_waitcnt vmcnt(0)
v_xor_b32 v60, s20, v225
v_xor_b32 v61, s20, v227
v_or_b32 v60, v60, v61
v_cmp_ne_u32 vcc, 0, v60
s_cbranch_vccz g2m_37
s_sub_u32 s26, s26, 1
s_cmp_eq_u32 s26, 0
s_cbranch_scc1 g2m_37
s_branch g2_35
g2m_37:
v_mov_b32 v228, v224
v_mov_b32 v230, v226
g2f_36:
v_lshlrev_b32 v33, 3, v0
v_add_u32 v33, 16384, v33
ds_write2_b32 v33, v228, v230 offset0:0 offset1:1
s_waitcnt lgkmcnt(0)
s_barrier
v_lshlrev_b32 v33, 5, v4
ds_read_b128 v[144:147], v33 offset:16384
ds_read_b128 v[148:151], v33 offset:16400
ds_read_b128 v[152:155], v33 offset:16896
ds_read_b128 v[156:159], v33 offset:16912
ds_read_b128 v[160:163], v33 offset:17408
ds_read_b128 v[164:167], v33 offset:17424
ds_read_b128 v[168:171], v33 offset:17920
ds_read_b128 v[172:175], v33 offset:17936
s_waitcnt lgkmcnt(0)
v_add_f32 v144, v144, v152
v_add_f32 v160, v160, v168
v_add_f32 v145, v145, v153
v_add_f32 v161, v161, v169
v_add_f32 v146, v146, v154
v_add_f32 v162, v162, v170
v_add_f32 v147, v147, v155
v_add_f32 v163, v163, v171
v_add_f32 v148, v148, v156
v_add_f32 v164, v164, v172
v_add_f32 v149, v149, v157
v_add_f32 v165, v165, v173
v_add_f32 v150, v150, v158
v_add_f32 v166, v166, v174
v_add_f32 v151, v151, v159
v_add_f32 v167, v167, v175
v_add_f32 v144, v144, v160
v_add_f32 v145, v145, v161
v_add_f32 v146, v146, v162
v_add_f32 v147, v147, v163
v_add_f32 v148, v148, v164
v_add_f32 v149, v149, v165
v_add_f32 v150, v150, v166
v_add_f32 v151, v151, v167
v_cvt_pk_bf16_f32 v40, v144, v145
v_cvt_pk_bf16_f32 v41, v146, v147
v_cvt_pk_bf16_f32 v42, v148, v149
v_cvt_pk_bf16_f32 v43, v150, v151
v_mov_b32 v20, 0
v_mov_b32 v21, 0
v_mov_b32 v22, 0
v_mov_b32 v23, 0
v_mov_b32 v24, 0
v_mov_b32 v25, 0
v_mov_b32 v26, 0
v_mov_b32 v27, 0
v_dot2c_f32_bf16 v20, v104, v40
v_dot2c_f32_bf16 v21, v108, v40
v_dot2c_f32_bf16 v22, v112, v40
v_dot2c_f32_bf16 v23, v116, v40
v_dot2c_f32_bf16 v24, v120, v40
v_dot2c_f32_bf16 v25, v124, v40
v_dot2c_f32_bf16 v26, v128, v40
v_dot2c_f32_bf16 v27, v132, v40
v_dot2c_f32_bf16 v20, v105, v41
v_dot2c_f32_bf16 v21, v109, v41
v_dot2c_f32_bf16 v22, v113, v41
v_dot2c_f32_bf16 v23, v117, v41
v_dot2c_f32_bf16 v24, v121, v41
v_dot2c_f32_bf16 v25, v125, v41
v_dot2c_f32_bf16 v26, v129, v41
v_dot2c_f32_bf16 v27, v133, v41
v_dot2c_f32_bf16 v20, v106, v42
v_dot2c_f32_bf16 v21, v110, v42
v_dot2c_f32_bf16 v22, v114, v42
v_dot2c_f32_bf16 v23, v118, v42
v_dot2c_f32_bf16 v24, v122, v42
v_dot2c_f32_bf16 v25, v126, v42
v_dot2c_f32_bf16 v26, v130, v42
v_dot2c_f32_bf16 v27, v134, v42
v_dot2c_f32_bf16 v20, v107, v43
v_dot2c_f32_bf16 v21, v111, v43
v_dot2c_f32_bf16 v22, v115, v43
v_dot2c_f32_bf16 v23, v119, v43
v_dot2c_f32_bf16 v24, v123, v43
v_dot2c_f32_bf16 v25, v127, v43
v_dot2c_f32_bf16 v26, v131, v43
v_dot2c_f32_bf16 v27, v135, v43
s_nop 2
v_add_f32_dpp v20, v20, v20 row_ror:1 row_mask:0xf bank_mask:0xf
v_add_f32_dpp v21, v21, v21 row_ror:1 row_mask:0xf bank_mask:0xf
v_add_f32_dpp v22, v22, v22 row_ror:1 row_mask:0xf bank_mask:0xf
v_add_f32_dpp v23, v23, v23 row_ror:1 row_mask:0xf bank_mask:0xf
v_add_f32_dpp v24, v24, v24 row_ror:1 row_mask:0xf bank_mask:0xf
v_add_f32_dpp v25, v25, v25 row_ror:1 row_mask:0xf bank_mask:0xf
v_add_f32_dpp v26, v26, v26 row_ror:1 row_mask:0xf bank_mask:0xf
v_add_f32_dpp v27, v27, v27 row_ror:1 row_mask:0xf bank_mask:0xf
v_add_f32_dpp v20, v20, v20 row_ror:2 row_mask:0xf bank_mask:0xf
v_add_f32_dpp v21, v21, v21 row_ror:2 row_mask:0xf bank_mask:0xf
v_add_f32_dpp v22, v22, v22 row_ror:2 row_mask:0xf bank_mask:0xf
v_add_f32_dpp v23, v23, v23 row_ror:2 row_mask:0xf bank_mask:0xf
v_add_f32_dpp v24, v24, v24 row_ror:2 row_mask:0xf bank_mask:0xf
v_add_f32_dpp v25, v25, v25 row_ror:2 row_mask:0xf bank_mask:0xf
v_add_f32_dpp v26, v26, v26 row_ror:2 row_mask:0xf bank_mask:0xf
v_add_f32_dpp v27, v27, v27 row_ror:2 row_mask:0xf bank_mask:0xf
v_add_f32_dpp v20, v20, v20 row_ror:4 row_mask:0xf bank_mask:0xf
v_add_f32_dpp v21, v21, v21 row_ror:4 row_mask:0xf bank_mask:0xf
v_add_f32_dpp v22, v22, v22 row_ror:4 row_mask:0xf bank_mask:0xf
v_add_f32_dpp v23, v23, v23 row_ror:4 row_mask:0xf bank_mask:0xf
v_add_f32_dpp v24, v24, v24 row_ror:4 row_mask:0xf bank_mask:0xf
v_add_f32_dpp v25, v25, v25 row_ror:4 row_mask:0xf bank_mask:0xf
v_add_f32_dpp v26, v26, v26 row_ror:4 row_mask:0xf bank_mask:0xf
v_add_f32_dpp v27, v27, v27 row_ror:4 row_mask:0xf bank_mask:0xf
v_add_f32_dpp v20, v20, v20 row_ror:8 row_mask:0xf bank_mask:0xf
v_add_f32_dpp v21, v21, v21 row_ror:8 row_mask:0xf bank_mask:0xf
v_add_f32_dpp v22, v22, v22 row_ror:8 row_mask:0xf bank_mask:0xf
v_add_f32_dpp v23, v23, v23 row_ror:8 row_mask:0xf bank_mask:0xf
v_add_f32_dpp v24, v24, v24 row_ror:8 row_mask:0xf bank_mask:0xf
v_add_f32_dpp v25, v25, v25 row_ror:8 row_mask:0xf bank_mask:0xf
v_add_f32_dpp v26, v26, v26 row_ror:8 row_mask:0xf bank_mask:0xf
v_add_f32_dpp v27, v27, v27 row_ror:8 row_mask:0xf bank_mask:0xf
s_mov_b32 s27, 0x3e0293ee
v_mul_f32 v20, s27, v20
v_mul_f32 v21, s27, v21
v_mul_f32 v22, s27, v22
v_mul_f32 v23, s27, v23
v_mul_f32 v24, s27, v24
v_mul_f32 v25, s27, v25
v_mul_f32 v26, s27, v26
v_mul_f32 v27, s27, v27
v_cvt_pk_bf16_f32 v40, v20, v21
v_cvt_pk_bf16_f32 v41, v22, v23
v_cvt_pk_bf16_f32 v42, v24, v25
v_cvt_pk_bf16_f32 v43, v26, v27
v_cmp_eq_u32 vcc, 1, v4
s_nop 1
v_cndmask_b32 v44, v40, v42, vcc
v_cndmask_b32 v46, v41, v43, vcc
v_mov_b32 v45, s20
v_mov_b32 v47, s20
v_lshlrev_b32 v33, 5, v3
v_lshl_add_u32 v33, v4, 4, v33
s_lshl_b32 s27, s31, 11
s_lshl_b32 s30, s32, 9
s_add_u32 s27, s27, s30
s_add_u32 s27, s27, 262144
v_cmp_gt_u32 vcc, 2, v4
s_and_saveexec_b64 s[28:29], vcc
s_cbranch_execz skip_39
buffer_store_dwordx4 v[44:47], v33, s[4:7], s27 offen sc1
skip_39:
s_mov_b64 exec, s[28:29]
s_mov_b32 s8, s44
s_mov_b32 s9, s45
s_mov_b32 s10, 0x400000
s_mov_b32 s11, 0x20000
s_lshl_b32 s27, s32, 20
s_lshl_b32 s30, s31, 8
s_add_u32 s27, s27, s30
s_add_u32 s30, s27, 0
buffer_load_dwordx4 v[64:67], v11, s[8:11], s30 offen nt
s_add_u32 s30, s27, 8192
buffer_load_dwordx4 v[68:71], v11, s[8:11], s30 offen nt
s_add_u32 s30, s27, 16384
buffer_load_dwordx4 v[72:75], v11, s[8:11], s30 offen nt
s_add_u32 s30, s27, 24576
buffer_load_dwordx4 v[76:79], v11, s[8:11], s30 offen nt
s_add_u32 s30, s27, 32768
buffer_load_dwordx4 v[80:83], v11, s[8:11], s30 offen nt
s_add_u32 s30, s27, 40960
buffer_load_dwordx4 v[84:87], v11, s[8:11], s30 offen nt
s_add_u32 s30, s27, 49152
buffer_load_dwordx4 v[88:91], v11, s[8:11], s30 offen nt
s_add_u32 s30, s27, 57344
buffer_load_dwordx4 v[92:95], v11, s[8:11], s30 offen nt
v_lshrrev_b32 v5, 3, v0
v_and_b32 v6, 7, v0
s_cmp_ge_u32 s22, 80
s_cbranch_scc1 L_no_wo
s_mov_b32 s12, s46
s_mov_b32 s13, s47
s_mov_b32 s14, 0x500000
s_mov_b32 s15, 0x20000
s_and_b32 s34, s22, 7
s_lshr_b32 s33, s22, 3
s_mov_b32 s27, 20480
v_mul_lo_u32 v12, v5, s27
v_lshl_add_u32 v12, v6, 4, v12
s_mul_i32 s27, s34, 655360
s_lshl_b32 s30, s33, 7
s_add_u32 s27, s27, s30
s_add_u32 s30, s27, 0
buffer_load_dwordx4 v[96:99], v12, s[12:15], s30 offen nt
s_add_u32 s30, s27, 1280
buffer_load_dwordx4 v[100:103], v12, s[12:15], s30 offen nt
s_add_u32 s30, s27, 2560
buffer_load_dwordx4 v[104:107], v12, s[12:15], s30 offen nt
s_add_u32 s30, s27, 3840
buffer_load_dwordx4 v[108:111], v12, s[12:15], s30 offen nt
s_add_u32 s30, s27, 5120
buffer_load_dwordx4 v[112:115], v12, s[12:15], s30 offen nt
s_add_u32 s30, s27, 6400
buffer_load_dwordx4 v[116:119], v12, s[12:15], s30 offen nt
s_add_u32 s30, s27, 7680
buffer_load_dwordx4 v[120:123], v12, s[12:15], s30 offen nt
s_add_u32 s30, s27, 8960
buffer_load_dwordx4 v[124:127], v12, s[12:15], s30 offen nt
s_add_u32 s30, s27, 10240
buffer_load_dwordx4 v[128:131], v12, s[12:15], s30 offen nt
s_add_u32 s30, s27, 11520
buffer_load_dwordx4 v[132:135], v12, s[12:15], s30 offen nt
s_add_u32 s30, s27, 12800
buffer_load_dwordx4 v[136:139], v12, s[12:15], s30 offen nt
s_add_u32 s30, s27, 14080
buffer_load_dwordx4 v[140:143], v12, s[12:15], s30 offen nt
s_add_u32 s30, s27, 15360
buffer_load_dwordx4 v[144:147], v12, s[12:15], s30 offen nt
s_add_u32 s30, s27, 16640
buffer_load_dwordx4 v[148:151], v12, s[12:15], s30 offen nt
s_add_u32 s30, s27, 17920
buffer_load_dwordx4 v[152:155], v12, s[12:15], s30 offen nt
s_add_u32 s30, s27, 19200
buffer_load_dwordx4 v[156:159], v12, s[12:15], s30 offen nt
s_waitcnt vmcnt(0)
v_perm_b32 v62, v100, v96, s24
v_perm_b32 v100, v100, v96, s25
v_mov_b32 v96, v62
v_perm_b32 v62, v101, v97, s24
v_perm_b32 v101, v101, v97, s25
v_mov_b32 v97, v62
v_perm_b32 v62, v102, v98, s24
v_perm_b32 v102, v102, v98, s25
v_mov_b32 v98, v62
v_perm_b32 v62, v103, v99, s24
v_perm_b32 v103, v103, v99, s25
v_mov_b32 v99, v62
v_perm_b32 v62, v108, v104, s24
v_perm_b32 v108, v108, v104, s25
v_mov_b32 v104, v62
v_perm_b32 v62, v109, v105, s24
v_perm_b32 v109, v109, v105, s25
v_mov_b32 v105, v62
v_perm_b32 v62, v110, v106, s24
v_perm_b32 v110, v110, v106, s25
v_mov_b32 v106, v62
v_perm_b32 v62, v111, v107, s24
v_perm_b32 v111, v111, v107, s25
v_mov_b32 v107, v62
v_perm_b32 v62, v116, v112, s24
v_perm_b32 v116, v116, v112, s25
v_mov_b32 v112, v62
v_perm_b32 v62, v117, v113, s24
v_perm_b32 v117, v117, v113, s25
v_mov_b32 v113, v62
v_perm_b32 v62, v118, v114, s24
v_perm_b32 v118, v118, v114, s25
v_mov_b32 v114, v62
v_perm_b32 v62, v119, v115, s24
v_perm_b32 v119, v119, v115, s25
v_mov_b32 v115, v62
v_perm_b32 v62, v124, v120, s24
v_perm_b32 v124, v124, v120, s25
v_mov_b32 v120, v62
v_perm_b32 v62, v125, v121, s24
v_perm_b32 v125, v125, v121, s25
v_mov_b32 v121, v62
v_perm_b32 v62, v126, v122, s24
v_perm_b32 v126, v126, v122, s25
v_mov_b32 v122, v62
v_perm_b32 v62, v127, v123, s24
v_perm_b32 v127, v127, v123, s25
v_mov_b32 v123, v62
v_perm_b32 v62, v132, v128, s24
v_perm_b32 v132, v132, v128, s25
v_mov_b32 v128, v62
v_perm_b32 v62, v133, v129, s24
v_perm_b32 v133, v133, v129, s25
v_mov_b32 v129, v62
v_perm_b32 v62, v134, v130, s24
v_perm_b32 v134, v134, v130, s25
v_mov_b32 v130, v62
v_perm_b32 v62, v135, v131, s24
v_perm_b32 v135, v135, v131, s25
v_mov_b32 v131, v62
v_perm_b32 v62, v140, v136, s24
v_perm_b32 v140, v140, v136, s25
v_mov_b32 v136, v62
v_perm_b32 v62, v141, v137, s24
v_perm_b32 v141, v141, v137, s25
v_mov_b32 v137, v62
v_perm_b32 v62, v142, v138, s24
v_perm_b32 v142, v142, v138, s25
v_mov_b32 v138, v62
v_perm_b32 v62, v143, v139, s24
v_perm_b32 v143, v143, v139, s25
v_mov_b32 v139, v62
v_perm_b32 v62, v148, v144, s24
v_perm_b32 v148, v148, v144, s25
v_mov_b32 v144, v62
v_perm_b32 v62, v149, v145, s24
v_perm_b32 v149, v149, v145, s25
v_mov_b32 v145, v62
v_perm_b32 v62, v150, v146, s24
v_perm_b32 v150, v150, v146, s25
v_mov_b32 v146, v62
v_perm_b32 v62, v151, v147, s24
v_perm_b32 v151, v151, v147, s25
v_mov_b32 v147, v62
v_perm_b32 v62, v156, v152, s24
v_perm_b32 v156, v156, v152, s25
v_mov_b32 v152, v62
v_perm_b32 v62, v157, v153, s24
v_perm_b32 v157, v157, v153, s25
v_mov_b32 v153, v62
v_perm_b32 v62, v158, v154, s24
v_perm_b32 v158, v158, v154, s25
v_mov_b32 v154, v62
v_perm_b32 v62, v159, v155, s24
v_perm_b32 v159, v159, v155, s25
v_mov_b32 v155, v62
s_branch L_late_done
L_no_wo:
s_cmp_ge_u32 s22, 120
s_cbranch_scc1 L_late_done
s_mov_b32 s12, s56
s_mov_b32 s13, s57
s_mov_b32 s14, 0x4b0000
s_mov_b32 s15, 0x20000
s_mov_b32 s16, s54
s_mov_b32 s17, s55
s_mov_b32 s18, 0x500
s_mov_b32 s19, 0x20000
v_mul_u32_u24 v7, 40, v5
buffer_load_dwordx2 v[40:41], v7, s[16:19], 0 offen offset:0
buffer_load_dwordx2 v[42:43], v7, s[16:19], 0 offen offset:8
buffer_load_dwordx2 v[44:45], v7, s[16:19], 0 offen offset:16
buffer_load_dwordx2 v[46:47], v7, s[16:19], 0 offen offset:24
buffer_load_dwordx2 v[48:49], v7, s[16:19], 0 offen offset:32
s_mov_b32 s27, 153600
v_mul_lo_u32 v12, v5, s27
v_lshl_add_u32 v12, v6, 4, v12
s_sub_u32 s33, s22, 80
s_lshl_b32 s33, s33, 7
s_add_u32 s27, s33, 2560
s_add_u32 s30, s27, 0
buffer_load_dwordx4 v[96:99], v12, s[12:15], s30 offen nt
s_add_u32 s30, s27, 7680
buffer_load_dwordx4 v[100:103], v12, s[12:15], s30 offen nt
s_add_u32 s30, s27, 15360
buffer_load_dwordx4 v[104:107], v12, s[12:15], s30 offen nt
s_add_u32 s30, s27, 23040
buffer_load_dwordx4 v[108:111], v12, s[12:15], s30 offen nt
s_add_u32 s30, s27, 30720
buffer_load_dwordx4 v[112:115], v12, s[12:15], s30 offen nt
s_add_u32 s30, s27, 38400
buffer_load_dwordx4 v[116:119], v12, s[12:15], s30 offen nt
s_add_u32 s30, s27, 46080
buffer_load_dwordx4 v[120:123], v12, s[12:15], s30 offen nt
s_add_u32 s30, s27, 53760
buffer_load_dwordx4 v[124:127], v12, s[12:15], s30 offen nt
s_add_u32 s30, s27, 61440
buffer_load_dwordx4 v[128:131], v12, s[12:15], s30 offen nt
s_add_u32 s30, s27, 69120
buffer_load_dwordx4 v[132:135], v12, s[12:15], s30 offen nt
s_add_u32 s30, s27, 76800
buffer_load_dwordx4 v[136:139], v12, s[12:15], s30 offen nt
s_add_u32 s30, s27, 84480
buffer_load_dwordx4 v[140:143], v12, s[12:15], s30 offen nt
s_waitcnt vmcnt(24)
s_add_u32 s30, s27, 92160
buffer_load_dwordx4 v[144:147], v12, s[12:15], s30 offen nt
s_waitcnt vmcnt(24)
s_add_u32 s30, s27, 99840
buffer_load_dwordx4 v[148:151], v12, s[12:15], s30 offen nt
s_waitcnt vmcnt(24)
s_add_u32 s30, s27, 107520
buffer_load_dwordx4 v[152:155], v12, s[12:15], s30 offen nt
s_waitcnt vmcnt(24)
s_add_u32 s30, s27, 115200
buffer_load_dwordx4 v[156:159], v12, s[12:15], s30 offen nt
s_waitcnt vmcnt(24)
s_add_u32 s30, s27, 122880
buffer_load_dwordx4 v[160:163], v12, s[12:15], s30 offen nt
s_waitcnt vmcnt(24)
s_add_u32 s30, s27, 130560
buffer_load_dwordx4 v[164:167], v12, s[12:15], s30 offen nt
s_waitcnt vmcnt(24)
s_add_u32 s30, s27, 138240
buffer_load_dwordx4 v[168:171], v12, s[12:15], s30 offen nt
s_waitcnt vmcnt(24)
s_add_u32 s30, s27, 145920
buffer_load_dwordx4 v[172:175], v12, s[12:15], s30 offen nt
s_waitcnt vmcnt(24)
s_waitcnt vmcnt(20)
v_lshlrev_b32 v52, 16, v40
v_and_b32 v53, 0xffff0000, v40
v_mul_f32 v54, 0xbfb8aa3b, v52
v_mul_f32 v55, 0xbfb8aa3b, v53
v_exp_f32 v54, v54
v_exp_f32 v55, v55
s_nop 0
v_add_f32 v54, 1.0, v54
v_add_f32 v55, 1.0, v55
v_rcp_f32 v54, v54
v_rcp_f32 v55, v55
s_nop 0
v_mul_f32 v52, v52, v54
v_mul_f32 v53, v53, v55
v_cvt_pk_bf16_f32 v40, v52, v53
v_lshlrev_b32 v52, 16, v41
v_and_b32 v53, 0xffff0000, v41
v_mul_f32 v54, 0xbfb8aa3b, v52
v_mul_f32 v55, 0xbfb8aa3b, v53
v_exp_f32 v54, v54
v_exp_f32 v55, v55
s_nop 0
v_add_f32 v54, 1.0, v54
v_add_f32 v55, 1.0, v55
v_rcp_f32 v54, v54
v_rcp_f32 v55, v55
s_nop 0
v_mul_f32 v52, v52, v54
v_mul_f32 v53, v53, v55
v_cvt_pk_bf16_f32 v41, v52, v53
v_lshlrev_b32 v52, 16, v42
v_and_b32 v53, 0xffff0000, v42
v_mul_f32 v54, 0xbfb8aa3b, v52
v_mul_f32 v55, 0xbfb8aa3b, v53
v_exp_f32 v54, v54
v_exp_f32 v55, v55
s_nop 0
v_add_f32 v54, 1.0, v54
v_add_f32 v55, 1.0, v55
v_rcp_f32 v54, v54
v_rcp_f32 v55, v55
s_nop 0
v_mul_f32 v52, v52, v54
v_mul_f32 v53, v53, v55
v_cvt_pk_bf16_f32 v42, v52, v53
v_lshlrev_b32 v52, 16, v43
v_and_b32 v53, 0xffff0000, v43
v_mul_f32 v54, 0xbfb8aa3b, v52
v_mul_f32 v55, 0xbfb8aa3b, v53
v_exp_f32 v54, v54
v_exp_f32 v55, v55
s_nop 0
v_add_f32 v54, 1.0, v54
v_add_f32 v55, 1.0, v55
v_rcp_f32 v54, v54
v_rcp_f32 v55, v55
s_nop 0
v_mul_f32 v52, v52, v54
v_mul_f32 v53, v53, v55
v_cvt_pk_bf16_f32 v43, v52, v53
v_lshlrev_b32 v52, 16, v44
v_and_b32 v53, 0xffff0000, v44
v_mul_f32 v54, 0xbfb8aa3b, v52
v_mul_f32 v55, 0xbfb8aa3b, v53
v_exp_f32 v54, v54
v_exp_f32 v55, v55
s_nop 0
v_add_f32 v54, 1.0, v54
v_add_f32 v55, 1.0, v55
v_rcp_f32 v54, v54
v_rcp_f32 v55, v55
s_nop 0
v_mul_f32 v52, v52, v54
v_mul_f32 v53, v53, v55
v_cvt_pk_bf16_f32 v44, v52, v53
v_lshlrev_b32 v52, 16, v45
v_and_b32 v53, 0xffff0000, v45
v_mul_f32 v54, 0xbfb8aa3b, v52
v_mul_f32 v55, 0xbfb8aa3b, v53
v_exp_f32 v54, v54
v_exp_f32 v55, v55
s_nop 0
v_add_f32 v54, 1.0, v54
v_add_f32 v55, 1.0, v55
v_rcp_f32 v54, v54
v_rcp_f32 v55, v55
s_nop 0
v_mul_f32 v52, v52, v54
v_mul_f32 v53, v53, v55
v_cvt_pk_bf16_f32 v45, v52, v53
v_lshlrev_b32 v52, 16, v46
v_and_b32 v53, 0xffff0000, v46
v_mul_f32 v54, 0xbfb8aa3b, v52
v_mul_f32 v55, 0xbfb8aa3b, v53
v_exp_f32 v54, v54
v_exp_f32 v55, v55
s_nop 0
v_add_f32 v54, 1.0, v54
v_add_f32 v55, 1.0, v55
v_rcp_f32 v54, v54
v_rcp_f32 v55, v55
s_nop 0
v_mul_f32 v52, v52, v54
v_mul_f32 v53, v53, v55
v_cvt_pk_bf16_f32 v46, v52, v53
v_lshlrev_b32 v52, 16, v47
v_and_b32 v53, 0xffff0000, v47
v_mul_f32 v54, 0xbfb8aa3b, v52
v_mul_f32 v55, 0xbfb8aa3b, v53
v_exp_f32 v54, v54
v_exp_f32 v55, v55
s_nop 0
v_add_f32 v54, 1.0, v54
v_add_f32 v55, 1.0, v55
v_rcp_f32 v54, v54
v_rcp_f32 v55, v55
s_nop 0
v_mul_f32 v52, v52, v54
v_mul_f32 v53, v53, v55
v_cvt_pk_bf16_f32 v47, v52, v53
v_lshlrev_b32 v52, 16, v48
v_and_b32 v53, 0xffff0000, v48
v_mul_f32 v54, 0xbfb8aa3b, v52
v_mul_f32 v55, 0xbfb8aa3b, v53
v_exp_f32 v54, v54
v_exp_f32 v55, v55
s_nop 0
v_add_f32 v54, 1.0, v54
v_add_f32 v55, 1.0, v55
v_rcp_f32 v54, v54
v_rcp_f32 v55, v55
s_nop 0
v_mul_f32 v52, v52, v54
v_mul_f32 v53, v53, v55
v_cvt_pk_bf16_f32 v48, v52, v53
v_lshlrev_b32 v52, 16, v49
v_and_b32 v53, 0xffff0000, v49
v_mul_f32 v54, 0xbfb8aa3b, v52
v_mul_f32 v55, 0xbfb8aa3b, v53
v_exp_f32 v54, v54
v_exp_f32 v55, v55
s_nop 0
v_add_f32 v54, 1.0, v54
v_add_f32 v55, 1.0, v55
v_rcp_f32 v54, v54
v_rcp_f32 v55, v55
s_nop 0
v_mul_f32 v52, v52, v54
v_mul_f32 v53, v53, v55
v_cvt_pk_bf16_f32 v49, v52, v53
s_waitcnt vmcnt(0)
v_perm_b32 v62, v100, v96, s24
v_perm_b32 v100, v100, v96, s25
v_mov_b32 v96, v62
v_perm_b32 v62, v101, v97, s24
v_perm_b32 v101, v101, v97, s25
v_mov_b32 v97, v62
v_perm_b32 v62, v102, v98, s24
v_perm_b32 v102, v102, v98, s25
v_mov_b32 v98, v62
v_perm_b32 v62, v103, v99, s24
v_perm_b32 v103, v103, v99, s25
v_mov_b32 v99, v62
v_perm_b32 v62, v108, v104, s24
v_perm_b32 v108, v108, v104, s25
v_mov_b32 v104, v62
v_perm_b32 v62, v109, v105, s24
v_perm_b32 v109, v109, v105, s25
v_mov_b32 v105, v62
v_perm_b32 v62, v110, v106, s24
v_perm_b32 v110, v110, v106, s25
v_mov_b32 v106, v62
v_perm_b32 v62, v111, v107, s24
v_perm_b32 v111, v111, v107, s25
v_mov_b32 v107, v62
v_perm_b32 v62, v116, v112, s24
v_perm_b32 v116, v116, v112, s25
v_mov_b32 v112, v62
v_perm_b32 v62, v117, v113, s24
v_perm_b32 v117, v117, v113, s25
v_mov_b32 v113, v62
v_perm_b32 v62, v118, v114, s24
v_perm_b32 v118, v118, v114, s25
v_mov_b32 v114, v62
v_perm_b32 v62, v119, v115, s24
v_perm_b32 v119, v119, v115, s25
v_mov_b32 v115, v62
v_perm_b32 v62, v124, v120, s24
v_perm_b32 v124, v124, v120, s25
v_mov_b32 v120, v62
v_perm_b32 v62, v125, v121, s24
v_perm_b32 v125, v125, v121, s25
v_mov_b32 v121, v62
v_perm_b32 v62, v126, v122, s24
v_perm_b32 v126, v126, v122, s25
v_mov_b32 v122, v62
v_perm_b32 v62, v127, v123, s24
v_perm_b32 v127, v127, v123, s25
v_mov_b32 v123, v62
v_perm_b32 v62, v132, v128, s24
v_perm_b32 v132, v132, v128, s25
v_mov_b32 v128, v62
v_perm_b32 v62, v133, v129, s24
v_perm_b32 v133, v133, v129, s25
v_mov_b32 v129, v62
v_perm_b32 v62, v134, v130, s24
v_perm_b32 v134, v134, v130, s25
v_mov_b32 v130, v62
v_perm_b32 v62, v135, v131, s24
v_perm_b32 v135, v135, v131, s25
v_mov_b32 v131, v62
v_perm_b32 v62, v140, v136, s24
v_perm_b32 v140, v140, v136, s25
v_mov_b32 v136, v62
v_perm_b32 v62, v141, v137, s24
v_perm_b32 v141, v141, v137, s25
v_mov_b32 v137, v62
v_perm_b32 v62, v142, v138, s24
v_perm_b32 v142, v142, v138, s25
v_mov_b32 v138, v62
v_perm_b32 v62, v143, v139, s24
v_perm_b32 v143, v143, v139, s25
v_mov_b32 v139, v62
v_perm_b32 v62, v148, v144, s24
v_perm_b32 v148, v148, v144, s25
v_mov_b32 v144, v62
v_perm_b32 v62, v149, v145, s24
v_perm_b32 v149, v149, v145, s25
v_mov_b32 v145, v62
v_perm_b32 v62, v150, v146, s24
v_perm_b32 v150, v150, v146, s25
v_mov_b32 v146, v62
v_perm_b32 v62, v151, v147, s24
v_perm_b32 v151, v151, v147, s25
v_mov_b32 v147, v62
v_perm_b32 v62, v156, v152, s24
v_perm_b32 v156, v156, v152, s25
v_mov_b32 v152, v62
v_perm_b32 v62, v157, v153, s24
v_perm_b32 v157, v157, v153, s25
v_mov_b32 v153, v62
v_perm_b32 v62, v158, v154, s24
v_perm_b32 v158, v158, v154, s25
v_mov_b32 v154, v62
v_perm_b32 v62, v159, v155, s24
v_perm_b32 v159, v159, v155, s25
v_mov_b32 v155, v62
v_perm_b32 v62, v164, v160, s24
v_perm_b32 v164, v164, v160, s25
v_mov_b32 v160, v62
v_perm_b32 v62, v165, v161, s24
v_perm_b32 v165, v165, v161, s25
v_mov_b32 v161, v62
v_perm_b32 v62, v166, v162, s24
v_perm_b32 v166, v166, v162, s25
v_mov_b32 v162, v62
v_perm_b32 v62, v167, v163, s24
v_perm_b32 v167, v167, v163, s25
v_mov_b32 v163, v62
v_perm_b32 v62, v172, v168, s24
v_perm_b32 v172, v172, v168, s25
v_mov_b32 v168, v62
v_perm_b32 v62, v173, v169, s24
v_perm_b32 v173, v173, v169, s25
v_mov_b32 v169, v62
v_perm_b32 v62, v174, v170, s24
v_perm_b32 v174, v174, v170, s25
v_mov_b32 v170, v62
v_perm_b32 v62, v175, v171, s24
v_perm_b32 v175, v175, v171, s25
v_mov_b32 v171, v62
v_mov_b32 v20, 0
v_mov_b32 v21, 0
v_mov_b32 v22, 0
v_mov_b32 v23, 0
v_mov_b32 v24, 0
v_mov_b32 v25, 0
v_mov_b32 v26, 0
v_mov_b32 v27, 0
v_dot2c_f32_bf16 v20, v96, v40
v_dot2c_f32_bf16 v21, v100, v40
v_dot2c_f32_bf16 v22, v97, v40
v_dot2c_f32_bf16 v23, v101, v40
v_dot2c_f32_bf16 v24, v98, v40
v_dot2c_f32_bf16 v25, v102, v40
v_dot2c_f32_bf16 v26, v99, v40
v_dot2c_f32_bf16 v27, v103, v40
v_dot2c_f32_bf16 v20, v104, v41
v_dot2c_f32_bf16 v21, v108, v41
v_dot2c_f32_bf16 v22, v105, v41
v_dot2c_f32_bf16 v23, v109, v41
v_dot2c_f32_bf16 v24, v106, v41
v_dot2c_f32_bf16 v25, v110, v41
v_dot2c_f32_bf16 v26, v107, v41
v_dot2c_f32_bf16 v27, v111, v41
v_dot2c_f32_bf16 v20, v112, v42
v_dot2c_f32_bf16 v21, v116, v42
v_dot2c_f32_bf16 v22, v113, v42
v_dot2c_f32_bf16 v23, v117, v42
v_dot2c_f32_bf16 v24, v114, v42
v_dot2c_f32_bf16 v25, v118, v42
v_dot2c_f32_bf16 v26, v115, v42
v_dot2c_f32_bf16 v27, v119, v42
v_dot2c_f32_bf16 v20, v120, v43
v_dot2c_f32_bf16 v21, v124, v43
v_dot2c_f32_bf16 v22, v121, v43
v_dot2c_f32_bf16 v23, v125, v43
v_dot2c_f32_bf16 v24, v122, v43
v_dot2c_f32_bf16 v25, v126, v43
v_dot2c_f32_bf16 v26, v123, v43
v_dot2c_f32_bf16 v27, v127, v43
v_dot2c_f32_bf16 v20, v128, v44
v_dot2c_f32_bf16 v21, v132, v44
v_dot2c_f32_bf16 v22, v129, v44
v_dot2c_f32_bf16 v23, v133, v44
v_dot2c_f32_bf16 v24, v130, v44
v_dot2c_f32_bf16 v25, v134, v44
v_dot2c_f32_bf16 v26, v131, v44
v_dot2c_f32_bf16 v27, v135, v44
v_dot2c_f32_bf16 v20, v136, v45
v_dot2c_f32_bf16 v21, v140, v45
v_dot2c_f32_bf16 v22, v137, v45
v_dot2c_f32_bf16 v23, v141, v45
v_dot2c_f32_bf16 v24, v138, v45
v_dot2c_f32_bf16 v25, v142, v45
v_dot2c_f32_bf16 v26, v139, v45
v_dot2c_f32_bf16 v27, v143, v45
v_dot2c_f32_bf16 v20, v144, v46
v_dot2c_f32_bf16 v21, v148, v46
v_dot2c_f32_bf16 v22, v145, v46
v_dot2c_f32_bf16 v23, v149, v46
v_dot2c_f32_bf16 v24, v146, v46
v_dot2c_f32_bf16 v25, v150, v46
v_dot2c_f32_bf16 v26, v147, v46
v_dot2c_f32_bf16 v27, v151, v46
v_dot2c_f32_bf16 v20, v152, v47
v_dot2c_f32_bf16 v21, v156, v47
v_dot2c_f32_bf16 v22, v153, v47
v_dot2c_f32_bf16 v23, v157, v47
v_dot2c_f32_bf16 v24, v154, v47
v_dot2c_f32_bf16 v25, v158, v47
v_dot2c_f32_bf16 v26, v155, v47
v_dot2c_f32_bf16 v27, v159, v47
v_dot2c_f32_bf16 v20, v160, v48
v_dot2c_f32_bf16 v21, v164, v48
v_dot2c_f32_bf16 v22, v161, v48
v_dot2c_f32_bf16 v23, v165, v48
v_dot2c_f32_bf16 v24, v162, v48
v_dot2c_f32_bf16 v25, v166, v48
v_dot2c_f32_bf16 v26, v163, v48
v_dot2c_f32_bf16 v27, v167, v48
v_dot2c_f32_bf16 v20, v168, v49
v_dot2c_f32_bf16 v21, v172, v49
v_dot2c_f32_bf16 v22, v169, v49
v_dot2c_f32_bf16 v23, v173, v49
v_dot2c_f32_bf16 v24, v170, v49
v_dot2c_f32_bf16 v25, v174, v49
v_dot2c_f32_bf16 v26, v171, v49
v_dot2c_f32_bf16 v27, v175, v49
s_nop 2
v_add_f32_dpp v20, v20, v20 row_ror:8 row_mask:0xf bank_mask:0xf
v_add_f32_dpp v21, v21, v21 row_ror:8 row_mask:0xf bank_mask:0xf
v_add_f32_dpp v22, v22, v22 row_ror:8 row_mask:0xf bank_mask:0xf
v_add_f32_dpp v23, v23, v23 row_ror:8 row_mask:0xf bank_mask:0xf
v_add_f32_dpp v24, v24, v24 row_ror:8 row_mask:0xf bank_mask:0xf
v_add_f32_dpp v25, v25, v25 row_ror:8 row_mask:0xf bank_mask:0xf
v_add_f32_dpp v26, v26, v26 row_ror:8 row_mask:0xf bank_mask:0xf
v_add_f32_dpp v27, v27, v27 row_ror:8 row_mask:0xf bank_mask:0xf
v_lshrrev_b32 v33, 4, v0
v_mul_u32_u24 v33, 256, v33
v_and_b32 v61, 15, v0
v_lshl_add_u32 v33, v61, 5, v33
v_cmp_gt_u32 vcc, 8, v61
s_and_saveexec_b64 s[28:29], vcc
s_cbranch_execz skip_40
ds_write_b128 v33, v[20:23] offset:0
ds_write_b128 v33, v[24:27] offset:16
skip_40:
s_mov_b64 exec, s[28:29]
s_waitcnt lgkmcnt(0)
s_barrier
v_cmp_gt_u32 vcc, 32, v0
s_and_saveexec_b64 s[28:29], vcc
s_cbranch_execz skip_41
v_lshlrev_b32 v33, 3, v0
ds_read_b64 v[208:209], v33 offset:0
ds_read_b64 v[210:211], v33 offset:256
ds_read_b64 v[212:213], v33 offset:512
ds_read_b64 v[214:215], v33 offset:768
ds_read_b64 v[216:217], v33 offset:1024
ds_read_b64 v[218:219], v33 offset:1280
ds_read_b64 v[220:221], v33 offset:1536
ds_read_b64 v[222:223], v33 offset:1792
ds_read_b64 v[224:225], v33 offset:2048
ds_read_b64 v[226:227], v33 offset:2304
ds_read_b64 v[228:229], v33 offset:2560
ds_read_b64 v[230:231], v33 offset:2816
ds_read_b64 v[232:233], v33 offset:3072
ds_read_b64 v[234:235], v33 offset:3328
ds_read_b64 v[236:237], v33 offset:3584
ds_read_b64 v[238:239], v33 offset:3840
s_waitcnt lgkmcnt(0)
v_pk_add_f32 v[208:209], v[208:209], v[224:225]
v_pk_add_f32 v[210:211], v[210:211], v[226:227]
v_pk_add_f32 v[212:213], v[212:213], v[228:229]
v_pk_add_f32 v[214:215], v[214:215], v[230:231]
v_pk_add_f32 v[216:217], v[216:217], v[232:233]
v_pk_add_f32 v[218:219], v[218:219], v[234:235]
v_pk_add_f32 v[220:221], v[220:221], v[236:237]
v_pk_add_f32 v[222:223], v[222:223], v[238:239]
v_pk_add_f32 v[208:209], v[208:209], v[216:217]
v_pk_add_f32 v[210:211], v[210:211], v[218:219]
v_pk_add_f32 v[212:213], v[212:213], v[220:221]
v_pk_add_f32 v[214:215], v[214:215], v[222:223]
v_pk_add_f32 v[208:209], v[208:209], v[212:213]
v_pk_add_f32 v[210:211], v[210:211], v[214:215]
v_pk_add_f32 v[208:209], v[208:209], v[210:211]
v_mov_b32 v40, v208
v_mov_b32 v41, v209
v_mov_b32 v44, v40
v_mov_b32 v45, s20
v_mov_b32 v46, v41
v_mov_b32 v47, s20
s_lshl_b32 s27, s33, 2
s_add_u32 s27, s27, 393216
v_lshlrev_b32 v33, 4, v0
buffer_store_dwordx4 v[44:47], v33, s[4:7], s27 offen sc1
skip_41:
s_mov_b64 exec, s[28:29]
s_barrier
L_late_done:
s_waitcnt vmcnt(0)
v_perm_b32 v62, v68, v64, s24
v_perm_b32 v68, v68, v64, s25
v_mov_b32 v64, v62
v_perm_b32 v62, v69, v65, s24
v_perm_b32 v69, v69, v65, s25
v_mov_b32 v65, v62
v_perm_b32 v62, v70, v66, s24
v_perm_b32 v70, v70, v66, s25
v_mov_b32 v66, v62
v_perm_b32 v62, v71, v67, s24
v_perm_b32 v71, v71, v67, s25
v_mov_b32 v67, v62
v_perm_b32 v62, v76, v72, s24
v_perm_b32 v76, v76, v72, s25
v_mov_b32 v72, v62
v_perm_b32 v62, v77, v73, s24
v_perm_b32 v77, v77, v73, s25
v_mov_b32 v73, v62
v_perm_b32 v62, v78, v74, s24
v_perm_b32 v78, v78, v74, s25
v_mov_b32 v74, v62
v_perm_b32 v62, v79, v75, s24
v_perm_b32 v79, v79, v75, s25
v_mov_b32 v75, v62
v_perm_b32 v62, v84, v80, s24
v_perm_b32 v84, v84, v80, s25
v_mov_b32 v80, v62
v_perm_b32 v62, v85, v81, s24
v_perm_b32 v85, v85, v81, s25
v_mov_b32 v81, v62
v_perm_b32 v62, v86, v82, s24
v_perm_b32 v86, v86, v82, s25
v_mov_b32 v82, v62
v_perm_b32 v62, v87, v83, s24
v_perm_b32 v87, v87, v83, s25
v_mov_b32 v83, v62
v_perm_b32 v62, v92, v88, s24
v_perm_b32 v92, v92, v88, s25
v_mov_b32 v88, v62
v_perm_b32 v62, v93, v89, s24
v_perm_b32 v93, v93, v89, s25
v_mov_b32 v89, v62
v_perm_b32 v62, v94, v90, s24
v_perm_b32 v94, v94, v90, s25
v_mov_b32 v90, v62
v_perm_b32 v62, v95, v91, s24
v_perm_b32 v95, v95, v91, s25
v_mov_b32 v91, v62
s_mov_b32 s80, 0
v_lshlrev_b32 v33, 4, v1
s_lshl_b32 s27, s31, 11
s_add_u32 s27, s27, 524288
s_cmp_lg_u32 s21, 0
s_cbranch_scc1 pw0_43
s_mov_b32 s26, 100000
gp_44:
buffer_load_dwordx4 v[240:243], v33, s[4:7], s27 offen offset:0 sc1
s_waitcnt vmcnt(0)
v_xor_b32 v60, s20, v241
v_xor_b32 v61, s20, v243
v_or_b32 v60, v60, v61
v_cmp_ne_u32 vcc, 0, v60
s_cbranch_vccz gpd_45
s_sub_u32 s26, s26, 1
s_cmp_eq_u32 s26, 0
s_cbranch_scc1 gpd_45
s_sleep 4
s_branch gp_44
gpd_45:
pw0_43:
s_barrier
s_mov_b32 s26, 100000
g_46:
buffer_load_dwordx4 v[240:243], v33, s[4:7], s27 offen offset:0 sc1
buffer_load_dwordx4 v[244:247], v33, s[4:7], s27 offen offset:1024 sc1
s_waitcnt vmcnt(0)
v_xor_b32 v60, s20, v241
v_xor_b32 v61, s20, v243
v_or_b32 v60, v60, v61
v_xor_b32 v61, s20, v245
v_or_b32 v60, v60, v61
v_xor_b32 v61, s20, v247
v_or_b32 v60, v60, v61
v_cmp_ne_u32 vcc, 0, v60
s_cbranch_vccz gd_47
s_sub_u32 s26, s26, 1
s_cmp_eq_u32 s26, 0
s_cbranch_scc1 gd_47
s_sleep 3
s_branch g_46
gd_47:
v_lshlrev_b32 v34, 8, v3
v_lshl_add_u32 v34, v4, 4, v34
s_lshl_b32 s27, s101, 15
s_add_u32 s27, s27, 4194304
s_add_u32 s84, s27, 0
s_add_u32 s85, s27, 4096
s_add_u32 s86, s27, 8192
s_add_u32 s87, s27, 12288
s_add_u32 s88, s27, 16384
s_add_u32 s89, s27, 20480
s_add_u32 s90, s27, 24576
s_add_u32 s91, s27, 28672
buffer_load_dwordx4 v[208:211], v34, s[4:7], s84 offen sc1
buffer_load_dwordx4 v[212:215], v34, s[4:7], s85 offen sc1
buffer_load_dwordx4 v[216:219], v34, s[4:7], s86 offen sc1
buffer_load_dwordx4 v[220:223], v34, s[4:7], s87 offen sc1
buffer_load_dwordx4 v[224:227], v34, s[4:7], s88 offen sc1
buffer_load_dwordx4 v[228:231], v34, s[4:7], s89 offen sc1
buffer_load_dwordx4 v[232:235], v34, s[4:7], s90 offen sc1
buffer_load_dwordx4 v[236:239], v34, s[4:7], s91 offen sc1
v_max_f32 v48, v240, v244
s_nop 1
v_max_f32_dpp v48, v48, v48 row_ror:8 row_mask:0xf bank_mask:0xf
s_nop 1
v_max_f32_dpp v48, v48, v48 row_ror:4 row_mask:0xf bank_mask:0xf
s_nop 1
v_max_f32_dpp v48, v48, v48 row_ror:2 row_mask:0xf bank_mask:0xf
s_nop 1
v_max_f32_dpp v48, v48, v48 row_ror:1 row_mask:0xf bank_mask:0xf
s_nop 0
v_mov_b32 v49, v48
s_nop 1
v_permlane16_swap_b32 v49, v48
s_nop 1
v_max_f32 v48, v49, v48
s_nop 0
v_mov_b32 v49, v48
s_nop 1
v_permlane32_swap_b32 v49, v48
s_nop 1
v_max_f32 v48, v49, v48
v_sub_f32 v40, v240, v48
v_sub_f32 v44, v244, v48
v_exp_f32 v40, v40
v_exp_f32 v44, v44
s_nop 0
v_mul_f32 v48, v40, v242
v_fmac_f32 v48, v44, v246
s_lshl_b32 s27, s21, 9
s_add_u32 s27, s27, 32768
v_lshl_add_u32 v35, v1, 2, s27
ds_write_b32 v35, v40
ds_write_b32 v35, v44 offset:256
s_nop 1
v_add_f32_dpp v48, v48, v48 row_ror:8 row_mask:0xf bank_mask:0xf
s_nop 1
v_add_f32_dpp v48, v48, v48 row_ror:4 row_mask:0xf bank_mask:0xf
s_nop 1
v_add_f32_dpp v48, v48, v48 row_ror:2 row_mask:0xf bank_mask:0xf
s_nop 1
v_add_f32_dpp v48, v48, v48 row_ror:1 row_mask:0xf bank_mask:0xf
s_nop 0
v_mov_b32 v49, v48
s_nop 1
v_permlane16_swap_b32 v49, v48
s_nop 1
v_add_f32 v48, v49, v48
s_nop 0
v_mov_b32 v49, v48
s_nop 1
v_permlane32_swap_b32 v49, v48
s_nop 1
v_add_f32 v48, v49, v48
v_rcp_f32 v48, v48
s_waitcnt lgkmcnt(0)
v_add_u32 v35, 0, v3
v_subrev_u32 v35, s101, v35
v_and_b32 v35, 127, v35
v_lshl_add_u32 v35, v35, 2, s27
ds_read_b32 v50, v35
v_add_u32 v35, 16, v3
v_subrev_u32 v35, s101, v35
v_and_b32 v35, 127, v35
v_lshl_add_u32 v35, v35, 2, s27
ds_read_b32 v51, v35
v_add_u32 v35, 32, v3
v_subrev_u32 v35, s101, v35
v_and_b32 v35, 127, v35
v_lshl_add_u32 v35, v35, 2, s27
ds_read_b32 v52, v35
v_add_u32 v35, 48, v3
v_subrev_u32 v35, s101, v35
v_and_b32 v35, 127, v35
v_lshl_add_u32 v35, v35, 2, s27
ds_read_b32 v53, v35
v_add_u32 v35, 64, v3
v_subrev_u32 v35, s101, v35
v_and_b32 v35, 127, v35
v_lshl_add_u32 v35, v35, 2, s27
ds_read_b32 v54, v35
v_add_u32 v35, 80, v3
v_subrev_u32 v35, s101, v35
v_and_b32 v35, 127, v35
v_lshl_add_u32 v35, v35, 2, s27
ds_read_b32 v55, v35
v_add_u32 v35, 96, v3
v_subrev_u32 v35, s101, v35
v_and_b32 v35, 127, v35
v_lshl_add_u32 v35, v35, 2, s27
ds_read_b32 v56, v35
v_add_u32 v35, 112, v3
v_subrev_u32 v35, s101, v35
v_and_b32 v35, 127, v35
v_lshl_add_u32 v35, v35, 2, s27
ds_read_b32 v57, v35
v_mov_b32 v20, 0
v_mov_b32 v21, 0
v_mov_b32 v22, 0
v_mov_b32 v23, 0
v_mov_b32 v24, 0
v_mov_b32 v25, 0
v_mov_b32 v26, 0
v_mov_b32 v27, 0
s_waitcnt lgkmcnt(0)
s_waitcnt vmcnt(7)
v_lshlrev_b32 v60, 16, v208
v_and_b32 v61, 0xffff0000, v208
v_fmac_f32 v20, v60, v50
v_fmac_f32 v21, v61, v50
v_lshlrev_b32 v60, 16, v209
v_and_b32 v61, 0xffff0000, v209
v_fmac_f32 v22, v60, v50
v_fmac_f32 v23, v61, v50
v_lshlrev_b32 v60, 16, v210
v_and_b32 v61, 0xffff0000, v210
v_fmac_f32 v24, v60, v50
v_fmac_f32 v25, v61, v50
v_lshlrev_b32 v60, 16, v211
v_and_b32 v61, 0xffff0000, v211
v_fmac_f32 v26, v60, v50
v_fmac_f32 v27, v61, v50
s_waitcnt vmcnt(6)
v_lshlrev_b32 v60, 16, v212
v_and_b32 v61, 0xffff0000, v212
v_fmac_f32 v20, v60, v51
v_fmac_f32 v21, v61, v51
v_lshlrev_b32 v60, 16, v213
v_and_b32 v61, 0xffff0000, v213
v_fmac_f32 v22, v60, v51
v_fmac_f32 v23, v61, v51
v_lshlrev_b32 v60, 16, v214
v_and_b32 v61, 0xffff0000, v214
v_fmac_f32 v24, v60, v51
v_fmac_f32 v25, v61, v51
v_lshlrev_b32 v60, 16, v215
v_and_b32 v61, 0xffff0000, v215
v_fmac_f32 v26, v60, v51
v_fmac_f32 v27, v61, v51
s_waitcnt vmcnt(5)
v_lshlrev_b32 v60, 16, v216
v_and_b32 v61, 0xffff0000, v216
v_fmac_f32 v20, v60, v52
v_fmac_f32 v21, v61, v52
v_lshlrev_b32 v60, 16, v217
v_and_b32 v61, 0xffff0000, v217
v_fmac_f32 v22, v60, v52
v_fmac_f32 v23, v61, v52
v_lshlrev_b32 v60, 16, v218
v_and_b32 v61, 0xffff0000, v218
v_fmac_f32 v24, v60, v52
v_fmac_f32 v25, v61, v52
v_lshlrev_b32 v60, 16, v219
v_and_b32 v61, 0xffff0000, v219
v_fmac_f32 v26, v60, v52
v_fmac_f32 v27, v61, v52
s_waitcnt vmcnt(4)
v_lshlrev_b32 v60, 16, v220
v_and_b32 v61, 0xffff0000, v220
v_fmac_f32 v20, v60, v53
v_fmac_f32 v21, v61, v53
v_lshlrev_b32 v60, 16, v221
v_and_b32 v61, 0xffff0000, v221
v_fmac_f32 v22, v60, v53
v_fmac_f32 v23, v61, v53
v_lshlrev_b32 v60, 16, v222
v_and_b32 v61, 0xffff0000, v222
v_fmac_f32 v24, v60, v53
v_fmac_f32 v25, v61, v53
v_lshlrev_b32 v60, 16, v223
v_and_b32 v61, 0xffff0000, v223
v_fmac_f32 v26, v60, v53
v_fmac_f32 v27, v61, v53
s_waitcnt vmcnt(3)
v_lshlrev_b32 v60, 16, v224
v_and_b32 v61, 0xffff0000, v224
v_fmac_f32 v20, v60, v54
v_fmac_f32 v21, v61, v54
v_lshlrev_b32 v60, 16, v225
v_and_b32 v61, 0xffff0000, v225
v_fmac_f32 v22, v60, v54
v_fmac_f32 v23, v61, v54
v_lshlrev_b32 v60, 16, v226
v_and_b32 v61, 0xffff0000, v226
v_fmac_f32 v24, v60, v54
v_fmac_f32 v25, v61, v54
v_lshlrev_b32 v60, 16, v227
v_and_b32 v61, 0xffff0000, v227
v_fmac_f32 v26, v60, v54
v_fmac_f32 v27, v61, v54
s_waitcnt vmcnt(2)
v_lshlrev_b32 v60, 16, v228
v_and_b32 v61, 0xffff0000, v228
v_fmac_f32 v20, v60, v55
v_fmac_f32 v21, v61, v55
v_lshlrev_b32 v60, 16, v229
v_and_b32 v61, 0xffff0000, v229
v_fmac_f32 v22, v60, v55
v_fmac_f32 v23, v61, v55
v_lshlrev_b32 v60, 16, v230
v_and_b32 v61, 0xffff0000, v230
v_fmac_f32 v24, v60, v55
v_fmac_f32 v25, v61, v55
v_lshlrev_b32 v60, 16, v231
v_and_b32 v61, 0xffff0000, v231
v_fmac_f32 v26, v60, v55
v_fmac_f32 v27, v61, v55
s_waitcnt vmcnt(1)
v_lshlrev_b32 v60, 16, v232
v_and_b32 v61, 0xffff0000, v232
v_fmac_f32 v20, v60, v56
v_fmac_f32 v21, v61, v56
v_lshlrev_b32 v60, 16, v233
v_and_b32 v61, 0xffff0000, v233
v_fmac_f32 v22, v60, v56
v_fmac_f32 v23, v61, v56
v_lshlrev_b32 v60, 16, v234
v_and_b32 v61, 0xffff0000, v234
v_fmac_f32 v24, v60, v56
v_fmac_f32 v25, v61, v56
v_lshlrev_b32 v60, 16, v235
v_and_b32 v61, 0xffff0000, v235
v_fmac_f32 v26, v60, v56
v_fmac_f32 v27, v61, v56
s_waitcnt vmcnt(0)
v_lshlrev_b32 v60, 16, v236
v_and_b32 v61, 0xffff0000, v236
v_fmac_f32 v20, v60, v57
v_fmac_f32 v21, v61, v57
v_lshlrev_b32 v60, 16, v237
v_and_b32 v61, 0xffff0000, v237
v_fmac_f32 v22, v60, v57
v_fmac_f32 v23, v61, v57
v_lshlrev_b32 v60, 16, v238
v_and_b32 v61, 0xffff0000, v238
v_fmac_f32 v24, v60, v57
v_fmac_f32 v25, v61, v57
v_lshlrev_b32 v60, 16, v239
v_and_b32 v61, 0xffff0000, v239
v_fmac_f32 v26, v60, v57
v_fmac_f32 v27, v61, v57
v_lshrrev_b32 v33, 4, v0
v_mul_u32_u24 v33, 512, v33
v_and_b32 v61, 15, v0
v_lshl_add_u32 v33, v61, 5, v33
ds_write_b128 v33, v[20:23] offset:0
ds_write_b128 v33, v[24:27] offset:16
s_waitcnt lgkmcnt(0)
s_barrier
v_cmp_gt_u32 vcc, 64, v0
s_and_saveexec_b64 s[28:29], vcc
s_cbranch_execz skip_48
v_lshlrev_b32 v33, 3, v0
ds_read_b64 v[208:209], v33 offset:0
ds_read_b64 v[210:211], v33 offset:512
ds_read_b64 v[212:213], v33 offset:1024
ds_read_b64 v[214:215], v33 offset:1536
ds_read_b64 v[216:217], v33 offset:2048
ds_read_b64 v[218:219], v33 offset:2560
ds_read_b64 v[220:221], v33 offset:3072
ds_read_b64 v[222:223], v33 offset:3584
ds_read_b64 v[224:225], v33 offset:4096
ds_read_b64 v[226:227], v33 offset:4608
ds_read_b64 v[228:229], v33 offset:5120
ds_read_b64 v[230:231], v33 offset:5632
ds_read_b64 v[232:233], v33 offset:6144
ds_read_b64 v[234:235], v33 offset:6656
ds_read_b64 v[236:237], v33 offset:7168
ds_read_b64 v[238:239], v33 offset:7680
s_waitcnt lgkmcnt(0)
v_pk_add_f32 v[208:209], v[208:209], v[224:225]
v_pk_add_f32 v[210:211], v[210:211], v[226:227]
v_pk_add_f32 v[212:213], v[212:213], v[228:229]
v_pk_add_f32 v[214:215], v[214:215], v[230:231]
v_pk_add_f32 v[216:217], v[216:217], v[232:233]
v_pk_add_f32 v[218:219], v[218:219], v[234:235]
v_pk_add_f32 v[220:221], v[220:221], v[236:237]
v_pk_add_f32 v[222:223], v[222:223], v[238:239]
v_pk_add_f32 v[208:209], v[208:209], v[216:217]
v_pk_add_f32 v[210:211], v[210:211], v[218:219]
v_pk_add_f32 v[212:213], v[212:213], v[220:221]
v_pk_add_f32 v[214:215], v[214:215], v[222:223]
v_pk_add_f32 v[208:209], v[208:209], v[212:213]
v_pk_add_f32 v[210:211], v[210:211], v[214:215]
v_pk_add_f32 v[208:209], v[208:209], v[210:211]
v_mov_b32 v40, v208
v_mov_b32 v41, v209
v_mul_f32 v40, v40, v48
v_mul_f32 v41, v41, v48
v_cvt_pk_bf16_f32 v40, v40, v41
v_lshlrev_b32 v33, 2, v0
ds_write_b32 v33, v40 offset:8192
skip_48:
s_mov_b64 exec, s[28:29]
s_waitcnt lgkmcnt(0)
s_barrier
v_lshlrev_b32 v33, 4, v3
ds_read_b128 v[40:43], v33 offset:8192
s_waitcnt lgkmcnt(0)
v_mov_b32 v20, 0
v_mov_b32 v21, 0
v_mov_b32 v22, 0
v_mov_b32 v23, 0
v_mov_b32 v24, 0
v_mov_b32 v25, 0
v_mov_b32 v26, 0
v_mov_b32 v27, 0
v_dot2c_f32_bf16 v20, v64, v40
v_dot2c_f32_bf16 v21, v68, v40
v_dot2c_f32_bf16 v22, v65, v40
v_dot2c_f32_bf16 v23, v69, v40
v_dot2c_f32_bf16 v24, v66, v40
v_dot2c_f32_bf16 v25, v70, v40
v_dot2c_f32_bf16 v26, v67, v40
v_dot2c_f32_bf16 v27, v71, v40
v_dot2c_f32_bf16 v20, v72, v41
v_dot2c_f32_bf16 v21, v76, v41
v_dot2c_f32_bf16 v22, v73, v41
v_dot2c_f32_bf16 v23, v77, v41
v_dot2c_f32_bf16 v24, v74, v41
v_dot2c_f32_bf16 v25, v78, v41
v_dot2c_f32_bf16 v26, v75, v41
v_dot2c_f32_bf16 v27, v79, v41
v_dot2c_f32_bf16 v20, v80, v42
v_dot2c_f32_bf16 v21, v84, v42
v_dot2c_f32_bf16 v22, v81, v42
v_dot2c_f32_bf16 v23, v85, v42
v_dot2c_f32_bf16 v24, v82, v42
v_dot2c_f32_bf16 v25, v86, v42
v_dot2c_f32_bf16 v26, v83, v42
v_dot2c_f32_bf16 v27, v87, v42
v_dot2c_f32_bf16 v20, v88, v43
v_dot2c_f32_bf16 v21, v92, v43
v_dot2c_f32_bf16 v22, v89, v43
v_dot2c_f32_bf16 v23, v93, v43
v_dot2c_f32_bf16 v24, v90, v43
v_dot2c_f32_bf16 v25, v94, v43
v_dot2c_f32_bf16 v26, v91, v43
v_dot2c_f32_bf16 v27, v95, v43
s_nop 2
v_lshrrev_b32 v33, 4, v0
v_mul_u32_u24 v33, 512, v33
v_and_b32 v61, 15, v0
v_lshl_add_u32 v33, v61, 5, v33
ds_write_b128 v33, v[20:23] offset:16384
ds_write_b128 v33, v[24:27] offset:16400
s_waitcnt lgkmcnt(0)
s_barrier
v_cmp_gt_u32 vcc, 64, v0
s_and_saveexec_b64 s[28:29], vcc
s_cbranch_execz skip_49
v_lshlrev_b32 v33, 3, v0
ds_read_b64 v[208:209], v33 offset:16384
ds_read_b64 v[210:211], v33 offset:16896
ds_read_b64 v[212:213], v33 offset:17408
ds_read_b64 v[214:215], v33 offset:17920
ds_read_b64 v[216:217], v33 offset:18432
ds_read_b64 v[218:219], v33 offset:18944
ds_read_b64 v[220:221], v33 offset:19456
ds_read_b64 v[222:223], v33 offset:19968
ds_read_b64 v[224:225], v33 offset:20480
ds_read_b64 v[226:227], v33 offset:20992
ds_read_b64 v[228:229], v33 offset:21504
ds_read_b64 v[230:231], v33 offset:22016
ds_read_b64 v[232:233], v33 offset:22528
ds_read_b64 v[234:235], v33 offset:23040
ds_read_b64 v[236:237], v33 offset:23552
ds_read_b64 v[238:239], v33 offset:24064
s_waitcnt lgkmcnt(0)
v_pk_add_f32 v[208:209], v[208:209], v[224:225]
v_pk_add_f32 v[210:211], v[210:211], v[226:227]
v_pk_add_f32 v[212:213], v[212:213], v[228:229]
v_pk_add_f32 v[214:215], v[214:215], v[230:231]
v_pk_add_f32 v[216:217], v[216:217], v[232:233]
v_pk_add_f32 v[218:219], v[218:219], v[234:235]
v_pk_add_f32 v[220:221], v[220:221], v[236:237]
v_pk_add_f32 v[222:223], v[222:223], v[238:239]
v_pk_add_f32 v[208:209], v[208:209], v[216:217]
v_pk_add_f32 v[210:211], v[210:211], v[218:219]
v_pk_add_f32 v[212:213], v[212:213], v[220:221]
v_pk_add_f32 v[214:215], v[214:215], v[222:223]
v_pk_add_f32 v[208:209], v[208:209], v[212:213]
v_pk_add_f32 v[210:211], v[210:211], v[214:215]
v_pk_add_f32 v[208:209], v[208:209], v[210:211]
v_mov_b32 v40, v208
v_mov_b32 v41, v209
v_cvt_pk_bf16_f32 v40, v40, v41
v_mov_b32 v41, s20
s_lshl_b32 s27, s101, 9
s_add_u32 s27, s27, 655360
s_add_u32 s30, s27, 8388608
buffer_store_dwordx2 v[40:41], v33, s[4:7], s30 offen
buffer_store_dwordx2 v[40:41], v33, s[4:7], s27 offen sc1
skip_49:
s_mov_b64 exec, s[28:29]
s_cmp_ge_u32 s22, 80
s_cbranch_scc1 L_w_tailend
s_and_b32 s34, s22, 7
s_lshr_b32 s33, s22, 3
s_cmp_ge_u32 s21, 2
s_cbranch_scc1 L_p6_nog
v_lshrrev_b32 v33, 5, v0
v_lshlrev_b32 v33, 11, v33
v_and_b32 v34, 31, v0
v_lshl_add_u32 v33, v34, 4, v33
s_lshl_b32 s27, s34, 13
s_add_u32 s27, s27, 655360
s_mov_b32 s26, 100000
s_add_u32 s88, s27, 8388608
g2_50:
s_mov_b32 s35, 8
g2l_53:
buffer_load_dwordx4 v[160:163], v33, s[4:7], s88 offen offset:0 sc1
buffer_load_dwordx4 v[164:167], v33, s[4:7], s88 offen offset:512 sc1
buffer_load_dwordx4 v[168:171], v33, s[4:7], s88 offen offset:1024 sc1
buffer_load_dwordx4 v[172:175], v33, s[4:7], s88 offen offset:1536 sc1
s_waitcnt vmcnt(0)
v_xor_b32 v60, s20, v161
v_xor_b32 v61, s20, v163
v_or_b32 v60, v60, v61
v_xor_b32 v61, s20, v165
v_or_b32 v60, v60, v61
v_xor_b32 v61, s20, v167
v_or_b32 v60, v60, v61
v_xor_b32 v61, s20, v169
v_or_b32 v60, v60, v61
v_xor_b32 v61, s20, v171
v_or_b32 v60, v60, v61
v_xor_b32 v61, s20, v173
v_or_b32 v60, v60, v61
v_xor_b32 v61, s20, v175
v_or_b32 v60, v60, v61
v_cmp_ne_u32 vcc, 0, v60
s_cbranch_vccz g2f_51
s_sub_u32 s35, s35, 1
s_cmp_lg_u32 s35, 0
s_cbranch_scc1 g2l_53
buffer_load_dwordx4 v[224:227], v33, s[4:7], s27 offen offset:0 sc1
buffer_load_dwordx4 v[228:231], v33, s[4:7], s27 offen offset:512 sc1
buffer_load_dwordx4 v[232:235], v33, s[4:7], s27 offen offset:1024 sc1
buffer_load_dwordx4 v[236:239], v33, s[4:7], s27 offen offset:1536 sc1
s_waitcnt vmcnt(0)
v_xor_b32 v60, s20, v225
v_xor_b32 v61, s20, v227
v_or_b32 v60, v60, v61
v_xor_b32 v61, s20, v229
v_or_b32 v60, v60, v61
v_xor_b32 v61, s20, v231
v_or_b32 v60, v60, v61
v_xor_b32 v61, s20, v233
v_or_b32 v60, v60, v61
v_xor_b32 v61, s20, v235
v_or_b32 v60, v60, v61
v_xor_b32 v61, s20, v237
v_or_b32 v60, v60, v61
v_xor_b32 v61, s20, v239
v_or_b32 v60, v60, v61
v_cmp_ne_u32 vcc, 0, v60
s_cbranch_vccz g2m_52
s_sub_u32 s26, s26, 1
s_cmp_eq_u32 s26, 0
s_cbranch_scc1 g2m_52
s_branch g2_50
g2m_52:
v_mov_b32 v160, v224
v_mov_b32 v162, v226
v_mov_b32 v164, v228
v_mov_b32 v166, v230
v_mov_b32 v168, v232
v_mov_b32 v170, v234
v_mov_b32 v172, v236
v_mov_b32 v174, v238
g2f_51:
v_lshlrev_b32 v40, 16, v160
v_and_b32 v41, 0xffff0000, v160
v_lshlrev_b32 v60, 16, v164
v_and_b32 v61, 0xffff0000, v164
v_add_f32 v40, v40, v60
v_add_f32 v41, v41, v61
v_lshlrev_b32 v60, 16, v168
v_and_b32 v61, 0xffff0000, v168
v_add_f32 v40, v40, v60
v_add_f32 v41, v41, v61
v_lshlrev_b32 v60, 16, v172
v_and_b32 v61, 0xffff0000, v172
v_add_f32 v40, v40, v60
v_add_f32 v41, v41, v61
v_lshlrev_b32 v42, 16, v162
v_and_b32 v43, 0xffff0000, v162
v_lshlrev_b32 v60, 16, v166
v_and_b32 v61, 0xffff0000, v166
v_add_f32 v42, v42, v60
v_add_f32 v43, v43, v61
v_lshlrev_b32 v60, 16, v170
v_and_b32 v61, 0xffff0000, v170
v_add_f32 v42, v42, v60
v_add_f32 v43, v43, v61
v_lshlrev_b32 v60, 16, v174
v_and_b32 v61, 0xffff0000, v174
v_add_f32 v42, v42, v60
v_add_f32 v43, v43, v61
v_cvt_pk_bf16_f32 v40, v40, v41
v_cvt_pk_bf16_f32 v41, v42, v43
v_lshlrev_b32 v33, 3, v0
ds_write_b64 v33, v[40:41] offset:8192
L_p6_nog:
s_waitcnt lgkmcnt(0)
s_barrier
v_lshlrev_b32 v33, 5, v5
ds_read_b128 v[40:43], v33 offset:8192
ds_read_b128 v[44:47], v33 offset:8208
s_waitcnt lgkmcnt(0)
v_mov_b32 v20, 0
v_mov_b32 v21, 0
v_mov_b32 v22, 0
v_mov_b32 v23, 0
v_mov_b32 v24, 0
v_mov_b32 v25, 0
v_mov_b32 v26, 0
v_mov_b32 v27, 0
v_dot2c_f32_bf16 v20, v96, v40
v_dot2c_f32_bf16 v21, v100, v40
v_dot2c_f32_bf16 v22, v97, v40
v_dot2c_f32_bf16 v23, v101, v40
v_dot2c_f32_bf16 v24, v98, v40
v_dot2c_f32_bf16 v25, v102, v40
v_dot2c_f32_bf16 v26, v99, v40
v_dot2c_f32_bf16 v27, v103, v40
v_dot2c_f32_bf16 v20, v104, v41
v_dot2c_f32_bf16 v21, v108, v41
v_dot2c_f32_bf16 v22, v105, v41
v_dot2c_f32_bf16 v23, v109, v41
v_dot2c_f32_bf16 v24, v106, v41
v_dot2c_f32_bf16 v25, v110, v41
v_dot2c_f32_bf16 v26, v107, v41
v_dot2c_f32_bf16 v27, v111, v41
v_dot2c_f32_bf16 v20, v112, v42
v_dot2c_f32_bf16 v21, v116, v42
v_dot2c_f32_bf16 v22, v113, v42
v_dot2c_f32_bf16 v23, v117, v42
v_dot2c_f32_bf16 v24, v114, v42
v_dot2c_f32_bf16 v25, v118, v42
v_dot2c_f32_bf16 v26, v115, v42
v_dot2c_f32_bf16 v27, v119, v42
v_dot2c_f32_bf16 v20, v120, v43
v_dot2c_f32_bf16 v21, v124, v43
v_dot2c_f32_bf16 v22, v121, v43
v_dot2c_f32_bf16 v23, v125, v43
v_dot2c_f32_bf16 v24, v122, v43
v_dot2c_f32_bf16 v25, v126, v43
v_dot2c_f32_bf16 v26, v123, v43
v_dot2c_f32_bf16 v27, v127, v43
v_dot2c_f32_bf16 v20, v128, v44
v_dot2c_f32_bf16 v21, v132, v44
v_dot2c_f32_bf16 v22, v129, v44
v_dot2c_f32_bf16 v23, v133, v44
v_dot2c_f32_bf16 v24, v130, v44
v_dot2c_f32_bf16 v25, v134, v44
v_dot2c_f32_bf16 v26, v131, v44
v_dot2c_f32_bf16 v27, v135, v44
v_dot2c_f32_bf16 v20, v136, v45
v_dot2c_f32_bf16 v21, v140, v45
v_dot2c_f32_bf16 v22, v137, v45
v_dot2c_f32_bf16 v23, v141, v45
v_dot2c_f32_bf16 v24, v138, v45
v_dot2c_f32_bf16 v25, v142, v45
v_dot2c_f32_bf16 v26, v139, v45
v_dot2c_f32_bf16 v27, v143, v45
v_dot2c_f32_bf16 v20, v144, v46
v_dot2c_f32_bf16 v21, v148, v46
v_dot2c_f32_bf16 v22, v145, v46
v_dot2c_f32_bf16 v23, v149, v46
v_dot2c_f32_bf16 v24, v146, v46
v_dot2c_f32_bf16 v25, v150, v46
v_dot2c_f32_bf16 v26, v147, v46
v_dot2c_f32_bf16 v27, v151, v46
v_dot2c_f32_bf16 v20, v152, v47
v_dot2c_f32_bf16 v21, v156, v47
v_dot2c_f32_bf16 v22, v153, v47
v_dot2c_f32_bf16 v23, v157, v47
v_dot2c_f32_bf16 v24, v154, v47
v_dot2c_f32_bf16 v25, v158, v47
v_dot2c_f32_bf16 v26, v155, v47
v_dot2c_f32_bf16 v27, v159, v47
s_nop 2
v_add_f32_dpp v20, v20, v20 row_ror:8 row_mask:0xf bank_mask:0xf
v_add_f32_dpp v21, v21, v21 row_ror:8 row_mask:0xf bank_mask:0xf
v_add_f32_dpp v22, v22, v22 row_ror:8 row_mask:0xf bank_mask:0xf
v_add_f32_dpp v23, v23, v23 row_ror:8 row_mask:0xf bank_mask:0xf
v_add_f32_dpp v24, v24, v24 row_ror:8 row_mask:0xf bank_mask:0xf
v_add_f32_dpp v25, v25, v25 row_ror:8 row_mask:0xf bank_mask:0xf
v_add_f32_dpp v26, v26, v26 row_ror:8 row_mask:0xf bank_mask:0xf
v_add_f32_dpp v27, v27, v27 row_ror:8 row_mask:0xf bank_mask:0xf
v_lshrrev_b32 v33, 4, v0
v_mul_u32_u24 v33, 256, v33
v_and_b32 v61, 15, v0
v_lshl_add_u32 v33, v61, 5, v33
v_cmp_gt_u32 vcc, 8, v61
s_and_saveexec_b64 s[28:29], vcc
s_cbranch_execz skip_54
ds_write_b128 v33, v[20:23] offset:0
ds_write_b128 v33, v[24:27] offset:16
skip_54:
s_mov_b64 exec, s[28:29]
s_waitcnt lgkmcnt(0)
s_barrier
v_cmp_gt_u32 vcc, 32, v0
s_and_saveexec_b64 s[28:29], vcc
s_cbranch_execz skip_55
v_lshlrev_b32 v33, 3, v0
ds_read_b64 v[176:177], v33 offset:0
ds_read_b64 v[178:179], v33 offset:256
ds_read_b64 v[180:181], v33 offset:512
ds_read_b64 v[182:183], v33 offset:768
ds_read_b64 v[184:185], v33 offset:1024
ds_read_b64 v[186:187], v33 offset:1280
ds_read_b64 v[188:189], v33 offset:1536
ds_read_b64 v[190:191], v33 offset:1792
ds_read_b64 v[192:193], v33 offset:2048
ds_read_b64 v[194:195], v33 offset:2304
ds_read_b64 v[196:197], v33 offset:2560
ds_read_b64 v[198:199], v33 offset:2816
ds_read_b64 v[200:201], v33 offset:3072
ds_read_b64 v[202:203], v33 offset:3328
ds_read_b64 v[204:205], v33 offset:3584
ds_read_b64 v[206:207], v33 offset:3840
s_waitcnt lgkmcnt(0)
v_pk_add_f32 v[176:177], v[176:177], v[192:193]
v_pk_add_f32 v[178:179], v[178:179], v[194:195]
v_pk_add_f32 v[180:181], v[180:181], v[196:197]
v_pk_add_f32 v[182:183], v[182:183], v[198:199]
v_pk_add_f32 v[184:185], v[184:185], v[200:201]
v_pk_add_f32 v[186:187], v[186:187], v[202:203]
v_pk_add_f32 v[188:189], v[188:189], v[204:205]
v_pk_add_f32 v[190:191], v[190:191], v[206:207]
v_pk_add_f32 v[176:177], v[176:177], v[184:185]
v_pk_add_f32 v[178:179], v[178:179], v[186:187]
v_pk_add_f32 v[180:181], v[180:181], v[188:189]
v_pk_add_f32 v[182:183], v[182:183], v[190:191]
v_pk_add_f32 v[176:177], v[176:177], v[180:181]
v_pk_add_f32 v[178:179], v[178:179], v[182:183]
v_pk_add_f32 v[176:177], v[176:177], v[178:179]
v_mov_b32 v40, v176
v_mov_b32 v41, v177
v_cvt_pk_bf16_f32 v40, v40, v41
v_mov_b32 v41, s20
s_mul_i32 s27, s34, 2560
s_lshl_b32 s30, s33, 8
s_add_u32 s27, s27, s30
s_add_u32 s27, s27, 786432
buffer_store_dwordx2 v[40:41], v33, s[4:7], s27 offen sc1
skip_55:
s_mov_b64 exec, s[28:29]
L_w_tailend:
s_branch L_end
L_end:
L_exit:
s_endpgm
.section .rodata,"a"
.p2align 6
.amdhsa_kernel adaLN_cond__compressed_kv_cla__dense_activation_relu__decode_kernel
  .amdhsa_next_free_vgpr 512
  .amdhsa_next_free_sgpr 102
  .amdhsa_accum_offset 256
  .amdhsa_group_segment_fixed_size 0
  .amdhsa_kernarg_size 112
  .amdhsa_user_sgpr_count 2
  .amdhsa_user_sgpr_kernarg_segment_ptr 1
  .amdhsa_system_sgpr_workgroup_id_x 1
.end_amdhsa_kernel
```
